```python
import torch

def _softmax(x, axis=-1):
    return torch.softmax(x, dim=axis)
def _gelu(x):
    return torch.nn.functional.gelu(x, approximate="tanh")
def _silu(x):
    return torch.nn.functional.silu(x)
def _sigmoid(x):
    return torch.sigmoid(x)
def _layernorm(x, axis=-1, eps=1e-5):
    m = x.mean(dim=axis, keepdim=True)
    v = x.var(dim=axis, keepdim=True, unbiased=False)
    return (x - m) / torch.sqrt(v + eps)
def _scatter_add(tgt, idx, src, axis=0):
    return tgt.clone().index_add_(axis, idx, src)
def _segment_sum(src, seg, n):
    out = torch.zeros((n,) + src.shape[1:], dtype=src.dtype)
    return out.index_add_(0, seg, src)
def _pad(x, pw):
    flat = tuple(v for pair in reversed(pw) for v in pair)
    return torch.nn.functional.pad(x, flat)

kernel_name = 'parallel_sum__sliding_local_dilated__dense_activation_silu__prompt'

def setup_inputs():

    _w = (lambda a: (lambda t: t.to(torch.bfloat16) if t.is_floating_point() else t)(torch.as_tensor(a)))
    def _A_setup():
        B, S, D = 1, 2048, 512
        return {
            "x": _w((lambda *s: torch.randn(*s, dtype=torch.bfloat16) * 0.05)(B, S, D)),
            "wqkv": _w((lambda *s: torch.randn(*s, dtype=torch.bfloat16) * 0.05)(D, 3 * D)),
            "wo": _w((lambda *s: torch.randn(*s, dtype=torch.bfloat16) * 0.05)(D, D)),
        }
    _A_in = _A_setup()

    def _B_setup():
        B, S, D, F = 1, 2048, 512, 1792
        return {
            "x": _w((lambda *s: torch.randn(*s, dtype=torch.bfloat16) * 0.05)(B, S, D)),
            "w1": _w((lambda *s: torch.randn(*s, dtype=torch.bfloat16) * 0.8)(D, F) * (D ** -0.5)),
            "w2": _w((lambda *s: torch.randn(*s, dtype=torch.bfloat16) * 0.8)(F, D) * (F ** -0.5)),
        }
    _B_in = _B_setup()

    return {
        "A_x": _A_in["x"],
        "A_wqkv": _A_in["wqkv"],
        "A_wo": _A_in["wo"],
        "B_x": _B_in["x"],
        "B_w1": _B_in["w1"],
        "B_w2": _B_in["w2"],
    }

def reference(A_x, A_wqkv, A_wo, B_x, B_w1, B_w2):
    def _A_ref(x, wqkv, wo):
        B, S, D = x.shape
        H = 32; Dh = D // H
        W, dil = 8, 2
        qkv = (lambda x, *d: x.permute(*d))((x @ wqkv).reshape(B, S, 3, H, Dh), 2, 0, 3, 1, 4)
        q, k, v = qkv[0], qkv[1], qkv[2]
        scale = Dh ** -0.5
        pos = torch.arange(S)
        off = torch.arange(W) * dil
        idx = pos[:, None] - off[None, :]
        mask = idx >= 0
        idx_c = torch.where(mask, idx, 0).reshape(-1)
        kg = k[:, :, idx_c, :].reshape(B, H, S, W, Dh)
        vg = v[:, :, idx_c, :].reshape(B, H, S, W, Dh)
        logits = torch.einsum("bhsd,bhswd->bhsw", q, kg) * scale
        logits = torch.where(mask[None, None, :, :], logits, -1e9)
        attn = _softmax(logits, axis=-1)
        o = torch.einsum("bhsw,bhswd->bhsd", attn, vg)
        return (lambda x, *d: x.permute(*d))(o, 0, 2, 1, 3).reshape(B, S, D) @ wo

    def _B_ref(x, w1, w2):
        h = torch.einsum("bsd,df->bsf", x, w1)
        h = _silu(h)
        out = torch.einsum("bsf,fd->bsd", h, w2)
        return out

    x = A_x
    xn = _layernorm(x, axis=-1)
    return x + _A_ref(xn, A_wqkv, A_wo) + _B_ref(xn, B_w1, B_w2)
```

```asm
; @launch grid=(256,1,1) block=(768,1,1) lds=163840
.amdgcn_target "amdgcn-amd-amdhsa--gfx950"
.text
.globl parallel_sum__sliding_local_dilated__dense_activation_silu__prompt_kernel
.p2align 8
.type parallel_sum__sliding_local_dilated__dense_activation_silu__prompt_kernel,@function
parallel_sum__sliding_local_dilated__dense_activation_silu__prompt_kernel:
    s_cmp_ge_u32 s2, 256
    s_cbranch_scc1 L_END
    s_load_dwordx4 s[4:7], s[0:1], 0
    s_load_dwordx4 s[20:23], s[0:1], 32
    s_load_dwordx2 s[16:17], s[0:1], 64
    s_load_dwordx2 s[64:65], s[0:1], 16
    s_load_dwordx4 s[68:71], s[0:1], 48
    v_lshrrev_b32 v4, 6, v0
    v_and_b32 v0, 63, v0
    v_readfirstlane_b32 s3, v4
    s_nop 0
    s_sub_u32 s3, s3, 4
    s_and_b32 s24, s2, 7
    s_lshr_b32 s25, s2, 3
    s_cmp_ge_u32 s3, 8
    s_cbranch_scc1 L_NOCPF
    s_getpc_b64 s[44:45]
L_PC:
    s_sub_u32 s44, s44, L_PC-parallel_sum__sliding_local_dilated__dense_activation_silu__prompt_kernel
    s_subb_u32 s45, s45, 0
    s_and_b32 s36, s25, 31
    s_lshl_b32 s36, s36, 3
    s_add_u32 s36, s36, s3
    s_mul_i32 s36, s36, 2
    v_add_u32 v40, s36, v0
    v_lshlrev_b32 v40, 7, v40
    v_min_u32 v40, L_CODE_END-parallel_sum__sliding_local_dilated__dense_activation_silu__prompt_kernel-4, v40
    v_mov_b32 v41, s45
    v_add_co_u32 v40, vcc, s44, v40
    s_nop 1
    v_addc_co_u32 v41, vcc, 0, v41, vcc
    s_mov_b64 exec, 3
    global_load_dword v23, v[40:41], off
    s_mov_b64 exec, -1
L_NOCPF:
    s_and_b32 s36, s24, 1
    s_lshl_b32 s26, s36, 3
    s_and_b32 s27, s25, 7
    s_add_u32 s26, s26, s27
    s_lshr_b32 s37, s24, 1
    s_lshr_b32 s29, s25, 3
    s_lshl_b32 s28, s37, 1
    s_and_b32 s38, s29, 1
    s_add_u32 s28, s28, s38
    s_and_b32 s39, s29, 2
    s_lshl_b32 s39, s39, 2
    s_add_u32 s28, s28, s39
    s_lshl_b32 s34, s26, 7
    s_and_b32 s32, s3, 3
    s_mov_b32 s10, 0x200000
    s_mov_b32 s11, 0x20000
    s_mov_b32 s18, 11534336
    s_mov_b32 s19, 0x20000
    v_lshlrev_b32 v1, 4, v0
    s_cmp_lt_u32 s3, 8
    s_cbranch_scc1 L_COMPUTE
    s_setprio 3
    s_and_b32 s30, s27, 3
    s_lshl_b32 s30, s30, 1
    s_add_u32 s30, s30, s36
    s_add_u32 s30, s30, s37
    s_lshl_b32 s38, s38, 2
    s_add_u32 s30, s30, s38
    s_and_b32 s30, s30, 7
    s_lshr_b32 s33, s27, 2
    v_lshrrev_b32 v14, 3, v0
    v_and_b32 v15, 7, v0
    v_lshrrev_b32 v16, 1, v14
    v_xor_b32 v17, v15, v16
    v_lshlrev_b32 v17, 4, v17
    s_lshl_b32 s41, s33, 6
    v_xor_b32 v17, s41, v17
    s_and_b32 s36, s32, 1
    s_lshl_b32 s36, s36, 6
    s_add_u32 s36, s36, s34
    s_lshr_b32 s43, s32, 1
    s_add_u32 s36, s36, s43
    s_lshl_b32 s36, s36, 10
    v_lshlrev_b32 v18, 11, v14
    v_add3_u32 v4, v18, v17, s36
    v_xor_b32 v5, 64, v4
    v_add_u32 v5, 0x4000, v5
    s_lshl_b32 s44, s32, 12
    s_lshl_b32 s61, s30, 7
    s_add_u32 s63, s61, 0x8000
    s_waitcnt lgkmcnt(0)
    s_mov_b32 s8, s4
    s_mov_b32 s9, s5
    s_add_u32 m0, s44, 43008
    s_nop 0
    buffer_load_dwordx4 v4, s[8:11], s61 offen lds
    s_add_u32 m0, s44, 44032
    s_nop 0
    buffer_load_dwordx4 v5, s[8:11], s61 offen lds
    s_add_u32 m0, s44, 45056
    s_nop 0
    buffer_load_dwordx4 v4, s[8:11], s63 offen lds
    s_add_u32 m0, s44, 46080
    s_nop 0
    buffer_load_dwordx4 v5, s[8:11], s63 offen lds
    v_bfe_u32 v19, v0, 1, 2
    v_and_b32 v20, 1, v16
    v_xor_b32 v19, v19, v20
    v_lshlrev_b32 v19, 5, v19
    v_and_b32 v21, 1, v0
    v_lshl_or_b32 v19, v21, 4, v19
    s_lshl_b32 s36, s33, 1
    s_xor_b32 s42, s36, s32
    s_lshl_b32 s42, s42, 4
    v_add_u32 v20, s42, v14
    s_lshl_b32 s44, s32, 12
    s_mov_b32 s15, 0x20000
    s_lshl_b32 s67, s28, 3
    s_lshl_b32 s36, s32, 1
    s_add_u32 s67, s67, s36
    s_and_b32 s66, s67, 63
    s_lshl_b32 s66, s66, 1
    s_lshr_b32 s36, s67, 6
    s_add_u32 s66, s66, s36
    s_add_u32 s66, s66, s34
    s_lshl_b32 s66, s66, 10
    s_add_u32 s67, s67, s34
    v_lshrrev_b32 v23, 5, v0
    v_and_b32 v9, 0x1f0, v1
    v_lshl_add_u32 v9, v23, 11, v9
    s_cmp_lt_u32 s28, 8
    s_cbranch_scc1 LD_QKV
    s_sub_u32 s37, s28, 8
    s_mul_i32 s38, s37, 448
    s_and_b32 s39, s37, 1
    s_lshl_b32 s46, s39, 6
    s_add_u32 s46, s46, s38
    s_cmp_eq_u32 s39, 0
    s_cselect_b32 s47, 384, 0
    s_add_u32 s47, s47, s38
    v_mul_u32_u24 v6, 3584, v20
    v_add3_u32 v6, v6, v19, s46
    v_xor_b32 v7, 64, v6
    v_add_u32 v7, 28672, v7
    v_lshrrev_b32 v20, 2, v0
    v_add_u32 v20, s42, v20
    v_mul_u32_u24 v20, 3584, v20
    v_bfe_u32 v22, v0, 1, 1
    v_xor_b32 v22, v22, v23
    v_lshlrev_b32 v22, 5, v22
    v_lshl_or_b32 v22, v21, 4, v22
    v_add3_u32 v8, v20, v22, s47
    s_mul_i32 s45, s32, 6144
    s_lshl_b32 s46, s32, 10
    s_mov_b32 s14, 1835008
    s_waitcnt lgkmcnt(0)
    s_mov_b32 s8, s4
    s_mov_b32 s9, s5
    s_mov_b32 s12, s20
    s_mov_b32 s13, s21
    s_add_u32 s31, s30, 0
    s_and_b32 s31, s31, 7
    s_lshl_b32 s61, s31, 7
    s_mul_i32 s62, s31, 229376
    s_add_u32 s63, s61, 0x8000
    s_add_u32 m0, s45, 61440
    s_nop 0
    buffer_load_dwordx4 v6, s[12:15], s62 offen lds
    s_add_u32 m0, s45, 62336
    s_nop 0
    buffer_load_dwordx4 v6, s[12:15], s62 offen offset:128 lds
    s_add_u32 m0, s45, 63232
    s_nop 0
    buffer_load_dwordx4 v6, s[12:15], s62 offen offset:256 lds
    s_add_u32 m0, s45, 64512
    s_nop 0
    buffer_load_dwordx4 v7, s[12:15], s62 offen lds
    s_add_u32 m0, s45, 65408
    s_nop 0
    buffer_load_dwordx4 v7, s[12:15], s62 offen offset:128 lds
    s_add_u32 m0, s45, 66304
    s_nop 0
    buffer_load_dwordx4 v7, s[12:15], s62 offen offset:256 lds
    s_add_u32 m0, s46, 147456
    s_nop 0
    buffer_load_dwordx4 v8, s[12:15], s62 offen lds
    buffer_load_dwordx4 v[152:155], v9, s[8:11], s66 offen
    buffer_load_dwordx4 v[156:159], v9, s[8:11], s66 offen offset:512
    s_lshl_b32 s48, s24, 2
    s_add_u32 s48, s48, s29
    s_mov_b32 s49, s27
    s_and_b32 s50, s29, 1
    s_lshl_b32 s50, s50, 1
    s_xor_b32 s50, s27, s50
    s_and_b32 s50, s50, 7
    s_and_b32 s54, s50, 3
    s_and_b32 s55, s50, 1
    s_lshl_b32 s53, s32, 2
    s_mul_i32 s58, s32, 14
    s_mov_b32 s72, s64
    s_mov_b32 s73, s65
    s_mov_b32 s74, 524288
    s_mov_b32 s75, 0x20000
    s_mov_b32 s76, s22
    s_mov_b32 s77, s23
    s_mov_b32 s78, 1835008
    s_mov_b32 s79, 0x20000
    v_bfe_u32 v20, v0, 1, 2
    v_lshrrev_b32 v22, 4, v0
    v_xor_b32 v20, v20, v22
    v_lshlrev_b32 v20, 5, v20
    v_lshl_or_b32 v20, v21, 4, v20
    s_lshl_b32 s36, s49, 7
    v_add_u32 v20, s36, v20
    v_lshl_add_u32 v11, v14, 10, v20
    v_lshl_add_u32 v10, v23, 12, v11
    v_add_u32 v9, s44, v1
    v_mov_b32 v16, 0
    v_mov_b32 v17, 0
    v_lshlrev_b32 v20, 2, v0
    v_add_u32 v20, 163328, v20
    ds_write_b32 v20, v16
    v_mov_b32 v21, 163328
    s_lshl_b32 s36, s32, 3
    s_add_u32 s36, s36, 163376
    v_mov_b32 v12, s36
    s_lshl_b32 s36, s32, 2
    s_add_u32 s36, s36, 163344
    v_mov_b32 v13, s36
    s_add_u32 s31, s30, 1
    s_and_b32 s31, s31, 7
    s_lshl_b32 s61, s31, 7
    s_mul_i32 s62, s31, 229376
    s_add_u32 s63, s61, 0x8000
    s_add_u32 m0, s44, 86016
    s_nop 0
    buffer_load_dwordx4 v4, s[8:11], s61 offen lds
    s_add_u32 m0, s45, 104448
    s_nop 0
    buffer_load_dwordx4 v6, s[12:15], s62 offen lds
    s_add_u32 m0, s44, 87040
    s_nop 0
    buffer_load_dwordx4 v5, s[8:11], s61 offen lds
    s_add_u32 m0, s45, 105344
    s_nop 0
    buffer_load_dwordx4 v6, s[12:15], s62 offen offset:128 lds
    s_add_u32 m0, s44, 88064
    s_nop 0
    buffer_load_dwordx4 v4, s[8:11], s63 offen lds
    s_add_u32 m0, s45, 106240
    s_nop 0
    buffer_load_dwordx4 v6, s[12:15], s62 offen offset:256 lds
    s_add_u32 m0, s44, 89088
    s_nop 0
    buffer_load_dwordx4 v5, s[8:11], s63 offen lds
    s_add_u32 m0, s45, 107520
    s_nop 0
    buffer_load_dwordx4 v7, s[12:15], s62 offen lds
    s_add_u32 m0, s45, 108416
    s_nop 0
    buffer_load_dwordx4 v7, s[12:15], s62 offen offset:128 lds
    s_add_u32 m0, s45, 109312
    s_nop 0
    buffer_load_dwordx4 v7, s[12:15], s62 offen offset:256 lds
    s_add_u32 m0, s46, 151552
    s_nop 0
    buffer_load_dwordx4 v8, s[12:15], s62 offen lds
    s_lshl_b32 s36, s48, 3
    s_add_u32 s36, s36, s49
    s_lshl_b32 s36, s36, 2
    s_add_u32 s36, s36, s32
    s_lshl_b32 s36, s36, 7
    s_add_u32 s36, s36, 11010048
    s_mov_b64 exec, 1
    buffer_store_dword v16, v16, s[16:19], s36 offen sc1
    s_mov_b64 exec, -1
    s_waitcnt vmcnt(14)
    s_waitcnt lgkmcnt(0)
    s_barrier
    s_waitcnt vmcnt(12)
    s_mov_b32 s36, 0x3f803f80
    v_dot2c_f32_bf16 v16, s36, v152
    v_dot2c_f32_bf16 v17, v152, v152
    v_dot2c_f32_bf16 v16, s36, v153
    v_dot2c_f32_bf16 v17, v153, v153
    v_dot2c_f32_bf16 v16, s36, v154
    v_dot2c_f32_bf16 v17, v154, v154
    v_dot2c_f32_bf16 v16, s36, v155
    v_dot2c_f32_bf16 v17, v155, v155
    v_dot2c_f32_bf16 v16, s36, v156
    v_dot2c_f32_bf16 v17, v156, v156
    v_dot2c_f32_bf16 v16, s36, v157
    v_dot2c_f32_bf16 v17, v157, v157
    v_dot2c_f32_bf16 v16, s36, v158
    v_dot2c_f32_bf16 v17, v158, v158
    v_dot2c_f32_bf16 v16, s36, v159
    v_dot2c_f32_bf16 v17, v159, v159
    s_nop 1
    v_add_f32_dpp v16, v16, v16 quad_perm:[1,0,3,2] row_mask:0xf bank_mask:0xf
    v_add_f32_dpp v17, v17, v17 quad_perm:[1,0,3,2] row_mask:0xf bank_mask:0xf
    s_nop 0
    v_add_f32_dpp v16, v16, v16 quad_perm:[2,3,0,1] row_mask:0xf bank_mask:0xf
    v_add_f32_dpp v17, v17, v17 quad_perm:[2,3,0,1] row_mask:0xf bank_mask:0xf
    s_nop 0
    v_add_f32_dpp v16, v16, v16 row_half_mirror row_mask:0xf bank_mask:0xf
    v_add_f32_dpp v17, v17, v17 row_half_mirror row_mask:0xf bank_mask:0xf
    s_nop 0
    v_add_f32_dpp v16, v16, v16 row_mirror row_mask:0xf bank_mask:0xf
    v_add_f32_dpp v17, v17, v17 row_mirror row_mask:0xf bank_mask:0xf
    v_mov_b32 v18, v16
    v_mov_b32 v19, v17
    s_nop 0
    v_permlane16_swap_b32 v18, v16
    v_permlane16_swap_b32 v19, v17
    v_add_f32 v16, v16, v18
    v_add_f32 v17, v17, v19
    v_mul_f32 v16, 0x3b000000, v16
    v_mul_f32 v17, 0x3b000000, v17
    v_fma_f32 v17, -v16, v16, v17
    v_max_f32 v17, 0, v17
    v_cvt_pk_bf16_f32 v16, v16, v17
    v_and_b32 v17, 0xffff0000, v16
    v_lshlrev_b32 v16, 16, v16
    v_add_f32 v17, 0x3727c5ac, v17
    v_cvt_pk_bf16_f32 v17, v17, v17
    v_and_b32 v17, 0xffff0000, v17
    v_sqrt_f32 v17, v17
    s_nop 0
    v_cvt_pk_bf16_f32 v17, v17, v17
    v_and_b32 v17, 0xffff0000, v17
    v_rcp_f32 v18, v17
    v_sub_f32 v16, 0, v16
    v_mov_b32 v17, v16
    v_mov_b32 v19, v18
    s_lshl_b32 s36, s67, 4
    s_add_u32 s36, s36, 10485760
    v_lshlrev_b32 v22, 4, v23
    s_mov_b32 exec_lo, 1
    s_mov_b32 exec_hi, 1
    buffer_store_dwordx4 v[16:19], v22, s[16:19], s36 offen sc1
    s_mov_b64 exec, -1
    s_add_u32 s31, s30, 2
    s_and_b32 s31, s31, 7
    s_lshl_b32 s61, s31, 7
    s_mul_i32 s62, s31, 229376
    s_add_u32 s63, s61, 0x8000
    s_add_u32 m0, s44, 0
    s_nop 0
    buffer_load_dwordx4 v4, s[8:11], s61 offen lds
    s_add_u32 m0, s45, 18432
    s_nop 0
    buffer_load_dwordx4 v6, s[12:15], s62 offen lds
    s_add_u32 m0, s44, 1024
    s_nop 0
    buffer_load_dwordx4 v5, s[8:11], s61 offen lds
    s_add_u32 m0, s45, 19328
    s_nop 0
    buffer_load_dwordx4 v6, s[12:15], s62 offen offset:128 lds
    s_add_u32 m0, s44, 2048
    s_nop 0
    buffer_load_dwordx4 v4, s[8:11], s63 offen lds
    s_add_u32 m0, s45, 20224
    s_nop 0
    buffer_load_dwordx4 v6, s[12:15], s62 offen offset:256 lds
    s_add_u32 m0, s44, 3072
    s_nop 0
    buffer_load_dwordx4 v5, s[8:11], s63 offen lds
    s_add_u32 m0, s45, 21504
    s_nop 0
    buffer_load_dwordx4 v7, s[12:15], s62 offen lds
    s_add_u32 m0, s45, 22400
    s_nop 0
    buffer_load_dwordx4 v7, s[12:15], s62 offen offset:128 lds
    s_add_u32 m0, s45, 23296
    s_nop 0
    buffer_load_dwordx4 v7, s[12:15], s62 offen offset:256 lds
    s_add_u32 m0, s46, 155648
    s_nop 0
    buffer_load_dwordx4 v8, s[12:15], s62 offen lds
    s_waitcnt vmcnt(11)
    s_barrier
    s_cmp_lg_u32 s32, 0
    s_cbranch_scc1 LF_NOSIG
    s_and_b32 s36, s2, 15
    s_lshl_b32 s36, s36, 4
    v_mov_b32 v20, s36
    v_mov_b32 v22, 1
    s_mov_b64 exec, 1
    global_atomic_add v20, v22, s[70:71] sc1
    s_mov_b64 exec, -1
LF_NOSIG:
    s_add_u32 s31, s30, 3
    s_and_b32 s31, s31, 7
    s_lshl_b32 s61, s31, 7
    s_mul_i32 s62, s31, 229376
    s_add_u32 s63, s61, 0x8000
    s_add_u32 m0, s44, 43008
    s_nop 0
    buffer_load_dwordx4 v4, s[8:11], s61 offen lds
    s_add_u32 m0, s45, 61440
    s_nop 0
    buffer_load_dwordx4 v6, s[12:15], s62 offen lds
    s_add_u32 m0, s44, 44032
    s_nop 0
    buffer_load_dwordx4 v5, s[8:11], s61 offen lds
    s_add_u32 m0, s45, 62336
    s_nop 0
    buffer_load_dwordx4 v6, s[12:15], s62 offen offset:128 lds
    s_add_u32 m0, s44, 45056
    s_nop 0
    buffer_load_dwordx4 v4, s[8:11], s63 offen lds
    s_add_u32 m0, s45, 63232
    s_nop 0
    buffer_load_dwordx4 v6, s[12:15], s62 offen offset:256 lds
    s_add_u32 m0, s44, 46080
    s_nop 0
    buffer_load_dwordx4 v5, s[8:11], s63 offen lds
    s_add_u32 m0, s45, 64512
    s_nop 0
    buffer_load_dwordx4 v7, s[12:15], s62 offen lds
    s_add_u32 m0, s45, 65408
    s_nop 0
    buffer_load_dwordx4 v7, s[12:15], s62 offen offset:128 lds
    s_add_u32 m0, s45, 66304
    s_nop 0
    buffer_load_dwordx4 v7, s[12:15], s62 offen offset:256 lds
    s_add_u32 m0, s46, 147456
    s_nop 0
    buffer_load_dwordx4 v8, s[12:15], s62 offen lds
    s_waitcnt vmcnt(11)
    s_barrier
    s_add_u32 s31, s30, 4
    s_and_b32 s31, s31, 7
    s_lshl_b32 s61, s31, 7
    s_mul_i32 s62, s31, 229376
    s_add_u32 s63, s61, 0x8000
    s_add_u32 m0, s44, 86016
    s_nop 0
    buffer_load_dwordx4 v4, s[8:11], s61 offen lds
    s_add_u32 m0, s45, 104448
    s_nop 0
    buffer_load_dwordx4 v6, s[12:15], s62 offen lds
    s_add_u32 m0, s44, 87040
    s_nop 0
    buffer_load_dwordx4 v5, s[8:11], s61 offen lds
    s_add_u32 m0, s45, 105344
    s_nop 0
    buffer_load_dwordx4 v6, s[12:15], s62 offen offset:128 lds
    s_add_u32 m0, s44, 88064
    s_nop 0
    buffer_load_dwordx4 v4, s[8:11], s63 offen lds
    s_add_u32 m0, s45, 106240
    s_nop 0
    buffer_load_dwordx4 v6, s[12:15], s62 offen offset:256 lds
    s_add_u32 m0, s44, 89088
    s_nop 0
    buffer_load_dwordx4 v5, s[8:11], s63 offen lds
    s_add_u32 m0, s45, 107520
    s_nop 0
    buffer_load_dwordx4 v7, s[12:15], s62 offen lds
    s_add_u32 m0, s45, 108416
    s_nop 0
    buffer_load_dwordx4 v7, s[12:15], s62 offen offset:128 lds
    s_add_u32 m0, s45, 109312
    s_nop 0
    buffer_load_dwordx4 v7, s[12:15], s62 offen offset:256 lds
    s_add_u32 m0, s46, 151552
    s_nop 0
    buffer_load_dwordx4 v8, s[12:15], s62 offen lds
    s_waitcnt vmcnt(11)
    s_barrier
    s_add_u32 s31, s30, 5
    s_and_b32 s31, s31, 7
    s_lshl_b32 s61, s31, 7
    s_mul_i32 s62, s31, 229376
    s_add_u32 s63, s61, 0x8000
    s_add_u32 m0, s44, 0
    s_nop 0
    buffer_load_dwordx4 v4, s[8:11], s61 offen lds
    s_add_u32 m0, s45, 18432
    s_nop 0
    buffer_load_dwordx4 v6, s[12:15], s62 offen lds
    s_add_u32 m0, s44, 1024
    s_nop 0
    buffer_load_dwordx4 v5, s[8:11], s61 offen lds
    s_add_u32 m0, s45, 19328
    s_nop 0
    buffer_load_dwordx4 v6, s[12:15], s62 offen offset:128 lds
    s_add_u32 m0, s44, 2048
    s_nop 0
    buffer_load_dwordx4 v4, s[8:11], s63 offen lds
    s_add_u32 m0, s45, 20224
    s_nop 0
    buffer_load_dwordx4 v6, s[12:15], s62 offen offset:256 lds
    s_add_u32 m0, s44, 3072
    s_nop 0
    buffer_load_dwordx4 v5, s[8:11], s63 offen lds
    s_add_u32 m0, s45, 21504
    s_nop 0
    buffer_load_dwordx4 v7, s[12:15], s62 offen lds
    s_add_u32 m0, s45, 22400
    s_nop 0
    buffer_load_dwordx4 v7, s[12:15], s62 offen offset:128 lds
    s_add_u32 m0, s45, 23296
    s_nop 0
    buffer_load_dwordx4 v7, s[12:15], s62 offen offset:256 lds
    s_add_u32 m0, s46, 155648
    s_nop 0
    buffer_load_dwordx4 v8, s[12:15], s62 offen lds
    s_lshl_b32 s36, s2, 2
    s_add_u32 s36, s36, s32
    s_mul_i32 s42, s36, 512
    s_mul_i32 s43, s36, 1792
    v_lshlrev_b32 v20, 7, v0
    s_mov_b64 exec, 15
    buffer_load_dword v151, v20, s[72:75], s42 offen
    s_mov_b64 exec, 16383
    buffer_load_dword v151, v20, s[76:79], s43 offen
    s_mov_b64 exec, -1
    s_waitcnt vmcnt(13)
    s_barrier
    s_add_u32 s31, s30, 6
    s_and_b32 s31, s31, 7
    s_lshl_b32 s61, s31, 7
    s_mul_i32 s62, s31, 229376
    s_add_u32 s63, s61, 0x8000
    s_add_u32 m0, s44, 43008
    s_nop 0
    buffer_load_dwordx4 v4, s[8:11], s61 offen lds
    s_add_u32 m0, s45, 61440
    s_nop 0
    buffer_load_dwordx4 v6, s[12:15], s62 offen lds
    s_add_u32 m0, s44, 44032
    s_nop 0
    buffer_load_dwordx4 v5, s[8:11], s61 offen lds
    s_add_u32 m0, s45, 62336
    s_nop 0
    buffer_load_dwordx4 v6, s[12:15], s62 offen offset:128 lds
    s_add_u32 m0, s44, 45056
    s_nop 0
    buffer_load_dwordx4 v4, s[8:11], s63 offen lds
    s_add_u32 m0, s45, 63232
    s_nop 0
    buffer_load_dwordx4 v6, s[12:15], s62 offen offset:256 lds
    s_add_u32 m0, s44, 46080
    s_nop 0
    buffer_load_dwordx4 v5, s[8:11], s63 offen lds
    s_add_u32 m0, s45, 64512
    s_nop 0
    buffer_load_dwordx4 v7, s[12:15], s62 offen lds
    s_add_u32 m0, s45, 65408
    s_nop 0
    buffer_load_dwordx4 v7, s[12:15], s62 offen offset:128 lds
    s_add_u32 m0, s45, 66304
    s_nop 0
    buffer_load_dwordx4 v7, s[12:15], s62 offen offset:256 lds
    s_add_u32 m0, s46, 147456
    s_nop 0
    buffer_load_dwordx4 v8, s[12:15], s62 offen lds
    s_waitcnt vmcnt(13)
    s_barrier
    v_and_b32 v2, 0xf0, v1
    global_load_dword v3, v2, s[70:71] sc1
    s_add_u32 s31, s30, 7
    s_and_b32 s31, s31, 7
    s_lshl_b32 s61, s31, 7
    s_mul_i32 s62, s31, 229376
    s_add_u32 s63, s61, 0x8000
    s_add_u32 m0, s44, 86016
    s_nop 0
    buffer_load_dwordx4 v4, s[8:11], s61 offen lds
    s_add_u32 m0, s45, 104448
    s_nop 0
    buffer_load_dwordx4 v6, s[12:15], s62 offen lds
    s_add_u32 m0, s44, 87040
    s_nop 0
    buffer_load_dwordx4 v5, s[8:11], s61 offen lds
    s_add_u32 m0, s45, 105344
    s_nop 0
    buffer_load_dwordx4 v6, s[12:15], s62 offen offset:128 lds
    s_add_u32 m0, s44, 88064
    s_nop 0
    buffer_load_dwordx4 v4, s[8:11], s63 offen lds
    s_add_u32 m0, s45, 106240
    s_nop 0
    buffer_load_dwordx4 v6, s[12:15], s62 offen offset:256 lds
    s_add_u32 m0, s44, 89088
    s_nop 0
    buffer_load_dwordx4 v5, s[8:11], s63 offen lds
    s_add_u32 m0, s45, 107520
    s_nop 0
    buffer_load_dwordx4 v7, s[12:15], s62 offen lds
    s_add_u32 m0, s45, 108416
    s_nop 0
    buffer_load_dwordx4 v7, s[12:15], s62 offen offset:128 lds
    s_add_u32 m0, s45, 109312
    s_nop 0
    buffer_load_dwordx4 v7, s[12:15], s62 offen offset:256 lds
    s_add_u32 m0, s46, 151552
    s_nop 0
    buffer_load_dwordx4 v8, s[12:15], s62 offen lds
    s_mul_i32 s36, s32, 36
    v_add_u32 v4, s36, v0
    v_lshlrev_b32 v5, 4, v4
    s_sub_u32 s41, s26, 1
    s_max_i32 s41, s41, 0
    s_sub_u32 s41, s41, s26
    s_lshl_b32 s41, s41, 11
    s_add_u32 s41, s41, 896
    v_and_b32 v14, 0x70, v5
    v_and_b32 v15, 8, v4
    v_lshl_add_u32 v14, v15, 7, v14
    v_add_u32 v14, s41, v14
    v_cmp_gt_u32 vcc, 128, v4
    s_nop 1
    v_cndmask_b32 v14, v14, v5, vcc
    s_lshl_b32 s41, s26, 11
    s_add_u32 s41, s41, 10485760
    v_add_u32 v14, s41, v14
    v_add_u32 v5, 159744, v5
    s_lshl_b32 s42, s28, 14
    s_lshl_b32 s36, s32, 8
    s_add_u32 s42, s42, s36
    s_add_u32 s42, s42, 10616832
    v_lshrrev_b32 v23, 4, v0
    v_lshl_add_u32 v23, v23, 12, v2
    s_add_u32 s36, s36, 162048
    v_add_u32 v15, s36, v2
    s_waitcnt vmcnt(11)
    s_mov_b32 s61, 0
    s_branch LF_CNT_T
LF_CNT:
    s_sleep 4
    global_load_dword v3, v2, s[70:71] sc1
    s_add_u32 s61, s61, 1
    s_cmp_ge_u32 s61, 262144
    s_cbranch_scc1 LF_CNTOK
    s_waitcnt vmcnt(0)
LF_CNT_T:
    v_cmp_gt_u32 vcc, 16, v3
    s_nop 1
    s_cbranch_vccnz LF_CNT
LF_CNTOK:
    s_mov_b32 exec_hi, 15
    buffer_load_dwordx4 v[16:19], v14, s[16:19], 0 offen sc1
    s_mov_b32 exec_hi, -1
    buffer_load_dwordx4 v[152:155], v23, s[16:19], s42 offen offset:0 sc1
    buffer_load_dwordx4 v[156:159], v23, s[16:19], s42 offen offset:1024 sc1
    buffer_load_dwordx4 v[160:163], v23, s[16:19], s42 offen offset:2048 sc1
    buffer_load_dwordx4 v[164:167], v23, s[16:19], s42 offen offset:3072 sc1
    s_barrier
    s_xor_b32 s60, s50, 0
    s_and_b32 s36, s60, 4
    s_add_u32 s60, s60, s36
    s_add_u32 s60, s60, s58
    s_lshl_b32 s60, s60, 15
    s_add_u32 m0, s44, 0
    s_nop 0
    buffer_load_dwordx4 v11, s[76:79], s60 offen lds
    s_add_u32 s63, s60, 8192
    s_add_u32 m0, s44, 1024
    s_nop 0
    buffer_load_dwordx4 v11, s[76:79], s63 offen lds
    s_add_u32 s63, s60, 16384
    s_add_u32 m0, s44, 2048
    s_nop 0
    buffer_load_dwordx4 v11, s[76:79], s63 offen lds
    s_add_u32 s63, s60, 24576
    s_add_u32 m0, s44, 3072
    s_nop 0
    buffer_load_dwordx4 v11, s[76:79], s63 offen lds
    s_waitcnt vmcnt(9)
    v_mov_b32 v22, 1
    s_mov_b64 exec, 1
    ds_add_u32 v21, v22 offset:192
    s_mov_b64 exec, -1
    s_waitcnt vmcnt(8)
    s_mov_b32 exec_hi, 15
    ds_write_b128 v5, v[16:19]
    s_mov_b32 exec_hi, -1
    s_waitcnt vmcnt(4)
    v_add_f32 v152, v152, v156
    v_add_f32 v160, v160, v164
    v_add_f32 v153, v153, v157
    v_add_f32 v161, v161, v165
    v_add_f32 v154, v154, v158
    v_add_f32 v162, v162, v166
    v_add_f32 v155, v155, v159
    v_add_f32 v163, v163, v167
    v_add_f32 v152, v152, v160
    v_add_f32 v153, v153, v161
    v_add_f32 v154, v154, v162
    v_add_f32 v155, v155, v163
    v_mov_b32 v156, v152
    v_mov_b32 v157, v153
    v_mov_b32 v158, v154
    v_mov_b32 v159, v155
    v_permlane32_swap_b32 v156, v152
    v_permlane32_swap_b32 v157, v153
    v_permlane32_swap_b32 v158, v154
    v_permlane32_swap_b32 v159, v155
    v_add_f32 v152, v152, v156
    v_add_f32 v153, v153, v157
    v_add_f32 v154, v154, v158
    v_add_f32 v155, v155, v159
    v_mov_b32 v156, v152
    v_mov_b32 v157, v153
    v_mov_b32 v158, v154
    v_mov_b32 v159, v155
    v_permlane16_swap_b32 v156, v152
    v_permlane16_swap_b32 v157, v153
    v_permlane16_swap_b32 v158, v154
    v_permlane16_swap_b32 v159, v155
    v_add_f32 v152, v152, v156
    v_add_f32 v153, v153, v157
    v_add_f32 v154, v154, v158
    v_add_f32 v155, v155, v159
    ds_write_b128 v15, v[152:155]
    v_mov_b32 v22, 1
    s_mov_b64 exec, 1
    ds_add_u32 v21, v22 offset:8
    s_mov_b64 exec, -1
    s_lshl_b32 s41, s48, 3
    s_add_u32 s41, s41, s49
    s_lshl_b32 s41, s41, 2
    s_add_u32 s41, s41, s32
    s_lshl_b32 s41, s41, 7
    s_add_u32 s41, s41, 11010048
    s_and_b32 s36, s48, 1
    s_lshl_b32 s56, 0x50500000, s36
    s_lshl_b32 s62, 0x05050000, s36
    s_lshl_b32 s36, s36, 2
    s_lshl_b32 s42, 0x0f0f, s36
    s_and_b32 s36, s50, 4
    s_lshl_b32 s36, s36, 1
    s_lshl_b32 s43, 0xff0000, s36
    s_or_b32 s46, s42, s62
    s_and_b32 s43, s43, s62
    s_xor_b32 s62, s62, s43
    s_or_b32 s46, s46, s56
    v_and_b32 v4, 15, v0
    v_lshlrev_b32 v4, 7, v4
    v_lshrrev_b32 v5, 4, v0
    v_lshl_add_u32 v4, v5, 2, v4
    s_mov_b32 s98, 0
    v_mov_b32 v2, 0
    v_mov_b32 v3, 0
    v_mov_b32 v5, 0
    s_xor_b32 s60, s50, 1
    s_and_b32 s36, s60, 4
    s_add_u32 s60, s60, s36
    s_add_u32 s60, s60, s58
    s_lshl_b32 s60, s60, 15
    s_add_u32 m0, s44, 16384
    s_nop 0
    buffer_load_dwordx4 v11, s[76:79], s60 offen lds
    s_add_u32 s63, s60, 8192
    s_add_u32 m0, s44, 17408
    s_nop 0
    buffer_load_dwordx4 v11, s[76:79], s63 offen lds
    s_add_u32 s63, s60, 16384
    s_add_u32 m0, s44, 18432
    s_nop 0
    buffer_load_dwordx4 v11, s[76:79], s63 offen lds
    s_add_u32 s63, s60, 24576
    s_add_u32 m0, s44, 19456
    s_nop 0
    buffer_load_dwordx4 v11, s[76:79], s63 offen lds
    s_xor_b32 s60, s54, 0
    s_add_u32 s60, s60, s53
    s_lshl_b32 s60, s60, 15
    s_add_u32 m0, s44, 131072
    s_nop 0
    buffer_load_dwordx4 v10, s[72:75], s60 offen lds
    s_add_u32 s63, s60, 16384
    s_add_u32 m0, s44, 132096
    s_nop 0
    buffer_load_dwordx4 v10, s[72:75], s63 offen lds
    s_add_u32 s63, s60, 4096
    s_add_u32 m0, s44, 133120
    s_nop 0
    buffer_load_dwordx4 v10, s[72:75], s63 offen lds
    s_add_u32 s63, s60, 20480
    s_add_u32 m0, s44, 134144
    s_nop 0
    buffer_load_dwordx4 v10, s[72:75], s63 offen lds
    s_xor_b32 s60, s50, 5
    s_and_b32 s36, s60, 4
    s_add_u32 s60, s60, s36
    s_add_u32 s60, s60, s58
    s_lshl_b32 s60, s60, 15
    buffer_load_dwordx4 v[24:27], v11, s[76:79], s60 offen
    s_add_u32 s63, s60, 8192
    buffer_load_dwordx4 v[28:31], v11, s[76:79], s63 offen
    s_add_u32 s63, s60, 16384
    buffer_load_dwordx4 v[32:35], v11, s[76:79], s63 offen
    s_add_u32 s63, s60, 24576
    buffer_load_dwordx4 v[36:39], v11, s[76:79], s63 offen
    s_xor_b32 s60, s50, 6
    s_and_b32 s36, s60, 4
    s_add_u32 s60, s60, s36
    s_add_u32 s60, s60, s58
    s_lshl_b32 s60, s60, 15
    buffer_load_dwordx4 v[40:43], v11, s[76:79], s60 offen
    s_add_u32 s63, s60, 8192
    buffer_load_dwordx4 v[44:47], v11, s[76:79], s63 offen
    s_add_u32 s63, s60, 16384
    buffer_load_dwordx4 v[48:51], v11, s[76:79], s63 offen
    s_add_u32 s63, s60, 24576
    buffer_load_dwordx4 v[52:55], v11, s[76:79], s63 offen
    s_xor_b32 s60, s50, 7
    s_and_b32 s36, s60, 4
    s_add_u32 s60, s60, s36
    s_add_u32 s60, s60, s58
    s_lshl_b32 s60, s60, 15
    buffer_load_dwordx4 v[56:59], v11, s[76:79], s60 offen
    s_add_u32 s63, s60, 8192
    buffer_load_dwordx4 v[60:63], v11, s[76:79], s63 offen
    s_add_u32 s63, s60, 16384
    buffer_load_dwordx4 v[64:67], v11, s[76:79], s63 offen
    s_add_u32 s63, s60, 24576
    buffer_load_dwordx4 v[68:71], v11, s[76:79], s63 offen
    ds_read_b32 v22, v21 offset:120
    s_waitcnt lgkmcnt(0)
    v_readfirstlane_b32 s36, v22
    s_nop 0
    s_cmp_lt_u32 s36, 8
    s_cbranch_scc0 LF_SV1_OK
    s_mov_b32 s99, 0
LF_SV1:
    s_sleep 1
    s_add_u32 s99, s99, 1
    s_cmp_ge_u32 s99, 262144
    s_cbranch_scc1 LF_SV1_OK
    ds_read_b32 v22, v21 offset:120
    s_waitcnt lgkmcnt(0)
    v_readfirstlane_b32 s36, v22
    s_nop 0
    s_cmp_lt_u32 s36, 8
    s_cbranch_scc1 LF_SV1
LF_SV1_OK:
    s_xor_b32 s60, s50, 2
    s_and_b32 s36, s60, 4
    s_add_u32 s60, s60, s36
    s_add_u32 s60, s60, s58
    s_lshl_b32 s60, s60, 15
    s_add_u32 m0, s44, 32768
    s_nop 0
    buffer_load_dwordx4 v11, s[76:79], s60 offen lds
    s_add_u32 s63, s60, 8192
    s_add_u32 m0, s44, 33792
    s_nop 0
    buffer_load_dwordx4 v11, s[76:79], s63 offen lds
    s_add_u32 s63, s60, 16384
    s_add_u32 m0, s44, 34816
    s_nop 0
    buffer_load_dwordx4 v11, s[76:79], s63 offen lds
    s_add_u32 s63, s60, 24576
    s_add_u32 m0, s44, 35840
    s_nop 0
    buffer_load_dwordx4 v11, s[76:79], s63 offen lds
    s_xor_b32 s60, s50, 3
    s_and_b32 s36, s60, 4
    s_add_u32 s60, s60, s36
    s_add_u32 s60, s60, s58
    s_lshl_b32 s60, s60, 15
    s_add_u32 m0, s44, 49152
    s_nop 0
    buffer_load_dwordx4 v11, s[76:79], s60 offen lds
    s_add_u32 s63, s60, 8192
    s_add_u32 m0, s44, 50176
    s_nop 0
    buffer_load_dwordx4 v11, s[76:79], s63 offen lds
    s_add_u32 s63, s60, 16384
    s_add_u32 m0, s44, 51200
    s_nop 0
    buffer_load_dwordx4 v11, s[76:79], s63 offen lds
    s_add_u32 s63, s60, 24576
    s_add_u32 m0, s44, 52224
    s_nop 0
    buffer_load_dwordx4 v11, s[76:79], s63 offen lds
    s_xor_b32 s60, s50, 4
    s_and_b32 s36, s60, 4
    s_add_u32 s60, s60, s36
    s_add_u32 s60, s60, s58
    s_lshl_b32 s60, s60, 15
    s_add_u32 m0, s44, 65536
    s_nop 0
    buffer_load_dwordx4 v11, s[76:79], s60 offen lds
    s_add_u32 s63, s60, 8192
    s_add_u32 m0, s44, 66560
    s_nop 0
    buffer_load_dwordx4 v11, s[76:79], s63 offen lds
    s_add_u32 s63, s60, 16384
    s_add_u32 m0, s44, 67584
    s_nop 0
    buffer_load_dwordx4 v11, s[76:79], s63 offen lds
    s_add_u32 s63, s60, 24576
    s_add_u32 m0, s44, 68608
    s_nop 0
    buffer_load_dwordx4 v11, s[76:79], s63 offen lds
    s_xor_b32 s60, s54, 1
    s_add_u32 s60, s60, s53
    s_lshl_b32 s60, s60, 15
    buffer_load_dwordx4 v[72:75], v10, s[72:75], s60 offen
    s_add_u32 s63, s60, 16384
    buffer_load_dwordx4 v[76:79], v10, s[72:75], s63 offen
    s_add_u32 s63, s60, 4096
    buffer_load_dwordx4 v[80:83], v10, s[72:75], s63 offen
    s_add_u32 s63, s60, 20480
    buffer_load_dwordx4 v[84:87], v10, s[72:75], s63 offen
    s_xor_b32 s60, s54, 2
    s_add_u32 s60, s60, s53
    s_lshl_b32 s60, s60, 15
    buffer_load_dwordx4 v[88:91], v10, s[72:75], s60 offen
    s_add_u32 s63, s60, 16384
    buffer_load_dwordx4 v[92:95], v10, s[72:75], s63 offen
    s_add_u32 s63, s60, 4096
    buffer_load_dwordx4 v[96:99], v10, s[72:75], s63 offen
    s_add_u32 s63, s60, 20480
    buffer_load_dwordx4 v[100:103], v10, s[72:75], s63 offen
    s_waitcnt vmcnt(8)
    v_mov_b32 v22, 5
    ds_write_b32 v13, v22
    ds_read_b32 v22, v21 offset:124
    s_waitcnt lgkmcnt(0)
    v_readfirstlane_b32 s36, v22
    s_nop 0
    s_cmp_lt_u32 s36, 8
    s_cbranch_scc0 LF_SV2_OK
    s_mov_b32 s99, 0
LF_SV2:
    s_sleep 1
    s_add_u32 s99, s99, 1
    s_cmp_ge_u32 s99, 262144
    s_cbranch_scc1 LF_SV2_OK
    ds_read_b32 v22, v21 offset:124
    s_waitcnt lgkmcnt(0)
    v_readfirstlane_b32 s36, v22
    s_nop 0
    s_cmp_lt_u32 s36, 8
    s_cbranch_scc1 LF_SV2
LF_SV2_OK:
    v_add_u32 v20, 81920, v9
    ds_write_b128 v20, v[24:27] offset:0
    ds_write_b128 v20, v[28:31] offset:1024
    ds_write_b128 v20, v[32:35] offset:2048
    ds_write_b128 v20, v[36:39] offset:3072
    v_add_u32 v20, 98304, v9
    ds_write_b128 v20, v[40:43] offset:0
    ds_write_b128 v20, v[44:47] offset:1024
    ds_write_b128 v20, v[48:51] offset:2048
    ds_write_b128 v20, v[52:55] offset:3072
    v_add_u32 v20, 114688, v9
    ds_write_b128 v20, v[56:59] offset:0
    ds_write_b128 v20, v[60:63] offset:1024
    ds_write_b128 v20, v[64:67] offset:2048
    ds_write_b128 v20, v[68:71] offset:3072
    v_mov_b32 v22, 9
    ds_write_b32 v13, v22
    s_waitcnt lgkmcnt(0)
    ds_read_b64 v[16:17], v12
    s_waitcnt lgkmcnt(0)
    v_min_u32 v16, v16, v17
    s_nop 0
    v_readfirstlane_b32 s36, v16
    s_nop 0
    s_cmp_lt_u32 s36, 1
    s_cbranch_scc0 LF_SV3_OK
    s_mov_b32 s99, 0
LF_SV3:
    s_sleep 1
    s_add_u32 s99, s99, 1
    s_cmp_ge_u32 s99, 262144
    s_cbranch_scc1 LF_SV3_OK
    ds_read_b64 v[16:17], v12
    s_waitcnt lgkmcnt(0)
    v_min_u32 v16, v16, v17
    s_nop 0
    v_readfirstlane_b32 s36, v16
    s_nop 0
    s_cmp_lt_u32 s36, 1
    s_cbranch_scc1 LF_SV3
LF_SV3_OK:
    s_waitcnt vmcnt(4)
    v_add_u32 v20, 0, v9
    ds_write_b128 v20, v[72:75] offset:0
    ds_write_b128 v20, v[76:79] offset:1024
    ds_write_b128 v20, v[80:83] offset:2048
    ds_write_b128 v20, v[84:87] offset:3072
    v_mov_b32 v22, 10
    ds_write_b32 v13, v22
    ds_read_b64 v[16:17], v12
    s_waitcnt lgkmcnt(0)
    v_min_u32 v16, v16, v17
    s_nop 0
    v_readfirstlane_b32 s36, v16
    s_nop 0
    s_cmp_lt_u32 s36, 2
    s_cbranch_scc0 LF_SV4_OK
    s_mov_b32 s99, 0
LF_SV4:
    s_cmp_eq_u32 s98, s46
    s_cbranch_scc1 LF_SV4_NP
    s_load_dword s98, s[16:17], s41 glc
    s_waitcnt lgkmcnt(0)
    s_and_b32 s98, s98, s46
    v_mov_b32 v14, s98
    ds_write_b32 v13, v14 offset:16
LF_SV4_NP:
    s_sleep 1
    s_add_u32 s99, s99, 1
    s_cmp_ge_u32 s99, 262144
    s_cbranch_scc1 LF_SV4_OK
    ds_read_b64 v[16:17], v12
    s_waitcnt lgkmcnt(0)
    v_min_u32 v16, v16, v17
    s_nop 0
    v_readfirstlane_b32 s36, v16
    s_nop 0
    s_cmp_lt_u32 s36, 2
    s_cbranch_scc1 LF_SV4
LF_SV4_OK:
    s_waitcnt vmcnt(0)
    v_add_u32 v20, 16384, v9
    ds_write_b128 v20, v[88:91] offset:0
    ds_write_b128 v20, v[92:95] offset:1024
    ds_write_b128 v20, v[96:99] offset:2048
    ds_write_b128 v20, v[100:103] offset:3072
    v_mov_b32 v22, 11
    ds_write_b32 v13, v22
    ds_read_b64 v[16:17], v12
    s_waitcnt lgkmcnt(0)
    v_min_u32 v16, v16, v17
    s_nop 0
    v_readfirstlane_b32 s36, v16
    s_nop 0
    s_cmp_lt_u32 s36, 3
    s_cbranch_scc0 LF_SV5_OK
    s_mov_b32 s99, 0
LF_SV5:
    s_cmp_eq_u32 s98, s46
    s_cbranch_scc1 LF_SV5_NP
    s_load_dword s98, s[16:17], s41 glc
    s_waitcnt lgkmcnt(0)
    s_and_b32 s98, s98, s46
    v_mov_b32 v14, s98
    ds_write_b32 v13, v14 offset:16
LF_SV5_NP:
    s_sleep 1
    s_add_u32 s99, s99, 1
    s_cmp_ge_u32 s99, 262144
    s_cbranch_scc1 LF_SV5_OK
    ds_read_b64 v[16:17], v12
    s_waitcnt lgkmcnt(0)
    v_min_u32 v16, v16, v17
    s_nop 0
    v_readfirstlane_b32 s36, v16
    s_nop 0
    s_cmp_lt_u32 s36, 3
    s_cbranch_scc1 LF_SV5
LF_SV5_OK:
    s_xor_b32 s60, s54, 3
    s_add_u32 s60, s60, s53
    s_lshl_b32 s60, s60, 15
    s_add_u32 m0, s44, 32768
    s_nop 0
    buffer_load_dwordx4 v10, s[72:75], s60 offen lds
    s_add_u32 s63, s60, 16384
    s_add_u32 m0, s44, 33792
    s_nop 0
    buffer_load_dwordx4 v10, s[72:75], s63 offen lds
    s_add_u32 s63, s60, 4096
    s_add_u32 m0, s44, 34816
    s_nop 0
    buffer_load_dwordx4 v10, s[72:75], s63 offen lds
    s_add_u32 s63, s60, 20480
    s_add_u32 m0, s44, 35840
    s_nop 0
    buffer_load_dwordx4 v10, s[72:75], s63 offen lds
    ds_read_b64 v[16:17], v12
    s_waitcnt lgkmcnt(0)
    v_min_u32 v16, v16, v17
    s_nop 0
    v_readfirstlane_b32 s36, v16
    s_nop 0
    s_cmp_lt_u32 s36, 4
    s_cbranch_scc0 LF_SV6_OK
    s_mov_b32 s99, 0
    s_waitcnt vmcnt(0)
    v_mov_b32 v22, 12
    ds_write_b32 v13, v22
LF_SV6:
    s_cmp_eq_u32 s98, s46
    s_cbranch_scc1 LF_SV6_NP
    s_load_dword s98, s[16:17], s41 glc
    s_waitcnt lgkmcnt(0)
    s_and_b32 s98, s98, s46
    v_mov_b32 v14, s98
    ds_write_b32 v13, v14 offset:16
LF_SV6_NP:
    s_sleep 1
    s_add_u32 s99, s99, 1
    s_cmp_ge_u32 s99, 262144
    s_cbranch_scc1 LF_SV6_OK
    ds_read_b64 v[16:17], v12
    s_waitcnt lgkmcnt(0)
    v_min_u32 v16, v16, v17
    s_nop 0
    v_readfirstlane_b32 s36, v16
    s_nop 0
    s_cmp_lt_u32 s36, 4
    s_cbranch_scc1 LF_SV6
LF_SV6_OK:
    s_xor_b32 s60, s54, 0
    s_and_b32 s36, s60, 2
    s_mul_i32 s36, s36, 3
    s_add_u32 s60, s60, s36
    s_add_u32 s60, s60, s58
    s_add_u32 s60, s60, 4
    s_lshl_b32 s60, s60, 15
    s_add_u32 m0, s44, 49152
    s_nop 0
    buffer_load_dwordx4 v11, s[76:79], s60 offen lds
    s_add_u32 s63, s60, 8192
    s_add_u32 m0, s44, 50176
    s_nop 0
    buffer_load_dwordx4 v11, s[76:79], s63 offen lds
    s_add_u32 s63, s60, 16384
    s_add_u32 m0, s44, 51200
    s_nop 0
    buffer_load_dwordx4 v11, s[76:79], s63 offen lds
    s_add_u32 s63, s60, 24576
    s_add_u32 m0, s44, 52224
    s_nop 0
    buffer_load_dwordx4 v11, s[76:79], s63 offen lds
    ds_read_b64 v[16:17], v12
    s_waitcnt lgkmcnt(0)
    v_min_u32 v16, v16, v17
    s_nop 0
    v_readfirstlane_b32 s36, v16
    s_nop 0
    s_cmp_lt_u32 s36, 5
    s_cbranch_scc0 LF_SV7_OK
    s_mov_b32 s99, 0
    s_waitcnt vmcnt(0)
    v_mov_b32 v22, 13
    ds_write_b32 v13, v22
LF_SV7:
    s_cmp_eq_u32 s98, s46
    s_cbranch_scc1 LF_SV7_NP
    s_load_dword s98, s[16:17], s41 glc
    s_waitcnt lgkmcnt(0)
    s_and_b32 s98, s98, s46
    v_mov_b32 v14, s98
    ds_write_b32 v13, v14 offset:16
LF_SV7_NP:
    s_sleep 1
    s_add_u32 s99, s99, 1
    s_cmp_ge_u32 s99, 262144
    s_cbranch_scc1 LF_SV7_OK
    ds_read_b64 v[16:17], v12
    s_waitcnt lgkmcnt(0)
    v_min_u32 v16, v16, v17
    s_nop 0
    v_readfirstlane_b32 s36, v16
    s_nop 0
    s_cmp_lt_u32 s36, 5
    s_cbranch_scc1 LF_SV7
LF_SV7_OK:
    s_xor_b32 s60, s54, 1
    s_and_b32 s36, s60, 2
    s_mul_i32 s36, s36, 3
    s_add_u32 s60, s60, s36
    s_add_u32 s60, s60, s58
    s_add_u32 s60, s60, 4
    s_lshl_b32 s60, s60, 15
    s_add_u32 m0, s44, 65536
    s_nop 0
    buffer_load_dwordx4 v11, s[76:79], s60 offen lds
    s_add_u32 s63, s60, 8192
    s_add_u32 m0, s44, 66560
    s_nop 0
    buffer_load_dwordx4 v11, s[76:79], s63 offen lds
    s_add_u32 s63, s60, 16384
    s_add_u32 m0, s44, 67584
    s_nop 0
    buffer_load_dwordx4 v11, s[76:79], s63 offen lds
    s_add_u32 s63, s60, 24576
    s_add_u32 m0, s44, 68608
    s_nop 0
    buffer_load_dwordx4 v11, s[76:79], s63 offen lds
    s_waitcnt vmcnt(8)
    v_mov_b32 v22, 12
    s_mov_b64 exec, 1
    ds_max_u32 v13, v22
    s_mov_b64 exec, -1
    ds_read_b64 v[16:17], v12
    s_waitcnt lgkmcnt(0)
    v_min_u32 v16, v16, v17
    s_nop 0
    v_readfirstlane_b32 s36, v16
    s_nop 0
    s_cmp_lt_u32 s36, 6
    s_cbranch_scc0 LF_SV8_OK
    s_mov_b32 s99, 0
    s_waitcnt vmcnt(0)
    v_mov_b32 v22, 14
    ds_write_b32 v13, v22
LF_SV8:
    s_cmp_eq_u32 s98, s46
    s_cbranch_scc1 LF_SV8_NP
    s_load_dword s98, s[16:17], s41 glc
    s_waitcnt lgkmcnt(0)
    s_and_b32 s98, s98, s46
    v_mov_b32 v14, s98
    ds_write_b32 v13, v14 offset:16
LF_SV8_NP:
    s_sleep 1
    s_add_u32 s99, s99, 1
    s_cmp_ge_u32 s99, 262144
    s_cbranch_scc1 LF_SV8_OK
    ds_read_b64 v[16:17], v12
    s_waitcnt lgkmcnt(0)
    v_min_u32 v16, v16, v17
    s_nop 0
    v_readfirstlane_b32 s36, v16
    s_nop 0
    s_cmp_lt_u32 s36, 6
    s_cbranch_scc1 LF_SV8
LF_SV8_OK:
    s_xor_b32 s60, s54, 2
    s_and_b32 s36, s60, 2
    s_mul_i32 s36, s36, 3
    s_add_u32 s60, s60, s36
    s_add_u32 s60, s60, s58
    s_add_u32 s60, s60, 4
    s_lshl_b32 s60, s60, 15
    s_add_u32 m0, s44, 81920
    s_nop 0
    buffer_load_dwordx4 v11, s[76:79], s60 offen lds
    s_add_u32 s63, s60, 8192
    s_add_u32 m0, s44, 82944
    s_nop 0
    buffer_load_dwordx4 v11, s[76:79], s63 offen lds
    s_add_u32 s63, s60, 16384
    s_add_u32 m0, s44, 83968
    s_nop 0
    buffer_load_dwordx4 v11, s[76:79], s63 offen lds
    s_add_u32 s63, s60, 24576
    s_add_u32 m0, s44, 84992
    s_nop 0
    buffer_load_dwordx4 v11, s[76:79], s63 offen lds
    s_waitcnt vmcnt(8)
    v_mov_b32 v22, 13
    s_mov_b64 exec, 1
    ds_max_u32 v13, v22
    s_mov_b64 exec, -1
    ds_read_b64 v[16:17], v12
    s_waitcnt lgkmcnt(0)
    v_min_u32 v16, v16, v17
    s_nop 0
    v_readfirstlane_b32 s36, v16
    s_nop 0
    s_cmp_lt_u32 s36, 7
    s_cbranch_scc0 LF_SV9_OK
    s_mov_b32 s99, 0
    s_waitcnt vmcnt(0)
    v_mov_b32 v22, 15
    ds_write_b32 v13, v22
LF_SV9:
    s_cmp_eq_u32 s98, s46
    s_cbranch_scc1 LF_SV9_NP
    s_load_dword s98, s[16:17], s41 glc
    s_waitcnt lgkmcnt(0)
    s_and_b32 s98, s98, s46
    v_mov_b32 v14, s98
    ds_write_b32 v13, v14 offset:16
LF_SV9_NP:
    s_sleep 1
    s_add_u32 s99, s99, 1
    s_cmp_ge_u32 s99, 262144
    s_cbranch_scc1 LF_SV9_OK
    ds_read_b64 v[16:17], v12
    s_waitcnt lgkmcnt(0)
    v_min_u32 v16, v16, v17
    s_nop 0
    v_readfirstlane_b32 s36, v16
    s_nop 0
    s_cmp_lt_u32 s36, 7
    s_cbranch_scc1 LF_SV9
LF_SV9_OK:
    s_xor_b32 s60, s54, 3
    s_and_b32 s36, s60, 2
    s_mul_i32 s36, s36, 3
    s_add_u32 s60, s60, s36
    s_add_u32 s60, s60, s58
    s_add_u32 s60, s60, 4
    s_lshl_b32 s60, s60, 15
    s_add_u32 m0, s44, 98304
    s_nop 0
    buffer_load_dwordx4 v11, s[76:79], s60 offen lds
    s_add_u32 s63, s60, 8192
    s_add_u32 m0, s44, 99328
    s_nop 0
    buffer_load_dwordx4 v11, s[76:79], s63 offen lds
    s_add_u32 s63, s60, 16384
    s_add_u32 m0, s44, 100352
    s_nop 0
    buffer_load_dwordx4 v11, s[76:79], s63 offen lds
    s_add_u32 s63, s60, 24576
    s_add_u32 m0, s44, 101376
    s_nop 0
    buffer_load_dwordx4 v11, s[76:79], s63 offen lds
    s_waitcnt vmcnt(8)
    v_mov_b32 v22, 14
    s_mov_b64 exec, 1
    ds_max_u32 v13, v22
    s_mov_b64 exec, -1
    ds_read_b64 v[16:17], v12
    s_waitcnt lgkmcnt(0)
    v_min_u32 v16, v16, v17
    s_nop 0
    v_readfirstlane_b32 s36, v16
    s_nop 0
    s_cmp_lt_u32 s36, 8
    s_cbranch_scc0 LF_SV10_OK
    s_mov_b32 s99, 0
    s_waitcnt vmcnt(0)
    v_mov_b32 v22, 16
    ds_write_b32 v13, v22
LF_SV10:
    s_cmp_eq_u32 s98, s46
    s_cbranch_scc1 LF_SV10_NP
    s_load_dword s98, s[16:17], s41 glc
    s_waitcnt lgkmcnt(0)
    s_and_b32 s98, s98, s46
    v_mov_b32 v14, s98
    ds_write_b32 v13, v14 offset:16
LF_SV10_NP:
    s_sleep 1
    s_add_u32 s99, s99, 1
    s_cmp_ge_u32 s99, 262144
    s_cbranch_scc1 LF_SV10_OK
    ds_read_b64 v[16:17], v12
    s_waitcnt lgkmcnt(0)
    v_min_u32 v16, v16, v17
    s_nop 0
    v_readfirstlane_b32 s36, v16
    s_nop 0
    s_cmp_lt_u32 s36, 8
    s_cbranch_scc1 LF_SV10
LF_SV10_OK:
    s_xor_b32 s60, s55, 0
    s_add_u32 s60, s60, s58
    s_add_u32 s60, s60, 6
    s_lshl_b32 s60, s60, 15
    s_add_u32 m0, s44, 114688
    s_nop 0
    buffer_load_dwordx4 v10, s[76:79], s60 offen lds
    s_add_u32 s63, s60, 16384
    s_add_u32 m0, s44, 115712
    s_nop 0
    buffer_load_dwordx4 v10, s[76:79], s63 offen lds
    s_add_u32 s63, s60, 4096
    s_add_u32 m0, s44, 116736
    s_nop 0
    buffer_load_dwordx4 v10, s[76:79], s63 offen lds
    s_add_u32 s63, s60, 20480
    s_add_u32 m0, s44, 117760
    s_nop 0
    buffer_load_dwordx4 v10, s[76:79], s63 offen lds
    s_waitcnt vmcnt(8)
    v_mov_b32 v22, 15
    s_mov_b64 exec, 1
    ds_max_u32 v13, v22
    s_mov_b64 exec, -1
    ds_read_b64 v[16:17], v12
    s_waitcnt lgkmcnt(0)
    v_min_u32 v16, v16, v17
    s_nop 0
    v_readfirstlane_b32 s36, v16
    s_nop 0
    s_cmp_lt_u32 s36, 9
    s_cbranch_scc0 LF_SV11_OK
    s_mov_b32 s99, 0
    s_waitcnt vmcnt(0)
    v_mov_b32 v22, 17
    ds_write_b32 v13, v22
LF_SV11:
    s_cmp_eq_u32 s98, s46
    s_cbranch_scc1 LF_SV11_NP
    s_load_dword s98, s[16:17], s41 glc
    s_waitcnt lgkmcnt(0)
    s_and_b32 s98, s98, s46
    v_mov_b32 v14, s98
    ds_write_b32 v13, v14 offset:16
LF_SV11_NP:
    s_sleep 1
    s_add_u32 s99, s99, 1
    s_cmp_ge_u32 s99, 262144
    s_cbranch_scc1 LF_SV11_OK
    ds_read_b64 v[16:17], v12
    s_waitcnt lgkmcnt(0)
    v_min_u32 v16, v16, v17
    s_nop 0
    v_readfirstlane_b32 s36, v16
    s_nop 0
    s_cmp_lt_u32 s36, 9
    s_cbranch_scc1 LF_SV11
LF_SV11_OK:
    s_xor_b32 s60, s55, 1
    s_add_u32 s60, s60, s58
    s_add_u32 s60, s60, 6
    s_lshl_b32 s60, s60, 15
    s_add_u32 m0, s44, 131072
    s_nop 0
    buffer_load_dwordx4 v10, s[76:79], s60 offen lds
    s_add_u32 s63, s60, 16384
    s_add_u32 m0, s44, 132096
    s_nop 0
    buffer_load_dwordx4 v10, s[76:79], s63 offen lds
    s_add_u32 s63, s60, 4096
    s_add_u32 m0, s44, 133120
    s_nop 0
    buffer_load_dwordx4 v10, s[76:79], s63 offen lds
    s_add_u32 s63, s60, 20480
    s_add_u32 m0, s44, 134144
    s_nop 0
    buffer_load_dwordx4 v10, s[76:79], s63 offen lds
    s_waitcnt vmcnt(8)
    v_mov_b32 v22, 16
    s_mov_b64 exec, 1
    ds_max_u32 v13, v22
    s_mov_b64 exec, -1
    s_waitcnt vmcnt(4)
    v_mov_b32 v22, 17
    s_mov_b64 exec, 1
    ds_max_u32 v13, v22
    s_mov_b64 exec, -1
    s_waitcnt vmcnt(0)
    v_mov_b32 v22, 18
    s_mov_b64 exec, 1
    ds_max_u32 v13, v22
    s_mov_b64 exec, -1
    s_cmp_lg_u32 s98, s46
    s_cbranch_scc0 LF_SV12_OK
    s_mov_b32 s99, 0
LF_SV12:
    s_cmp_eq_u32 s98, s46
    s_cbranch_scc1 LF_SV12_NP
    s_load_dword s98, s[16:17], s41 glc
    s_waitcnt lgkmcnt(0)
    s_and_b32 s98, s98, s46
    v_mov_b32 v14, s98
    ds_write_b32 v13, v14 offset:16
LF_SV12_NP:
    s_sleep 1
    s_add_u32 s99, s99, 1
    s_cmp_ge_u32 s99, 262144
    s_cbranch_scc1 LF_SV12_OK
    s_cmp_lg_u32 s98, s46
    s_cbranch_scc1 LF_SV12
LF_SV12_OK:
    s_waitcnt lgkmcnt(0)
    s_endpgm
LD_QKV:
    s_lshl_b32 s36, s28, 7
    v_mul_u32_u24 v6, 3072, v20
    v_add3_u32 v6, v6, v19, s36
    v_xor_b32 v7, 64, v6
    v_add_u32 v7, 24576, v7
    s_lshl_b32 s36, s32, 2
    v_add_u32 v20, s36, v14
    v_lshrrev_b32 v22, 1, v20
    v_xor_b32 v22, v15, v22
    v_and_b32 v22, 7, v22
    v_lshlrev_b32 v22, 4, v22
    v_xor_b32 v22, s41, v22
    v_and_b32 v20, 7, v20
    v_lshl_add_u32 v22, v20, 11, v22
    s_add_u32 s36, s43, s34
    s_sub_u32 s36, s36, 16
    s_lshl_b32 s36, s36, 10
    v_add_u32 v8, s36, v22
    s_mul_i32 s45, s32, 6144
    s_lshl_b32 s46, s32, 9
    s_mov_b32 s14, 1572864
    s_waitcnt lgkmcnt(0)
    s_mov_b32 s8, s4
    s_mov_b32 s9, s5
    s_mov_b32 s12, s6
    s_mov_b32 s13, s7
    s_add_u32 s31, s30, 0
    s_and_b32 s31, s31, 7
    s_lshl_b32 s61, s31, 7
    s_mul_i32 s62, s31, 196608
    s_add_u32 s63, s61, 0x8000
    s_add_u32 m0, s45, 61440
    s_nop 0
    buffer_load_dwordx4 v6, s[12:15], s62 offen lds
    s_add_u32 m0, s45, 61440
    s_nop 0
    buffer_load_dwordx4 v6, s[12:15], s62 offen offset:1024 lds
    s_add_u32 m0, s45, 61440
    s_nop 0
    buffer_load_dwordx4 v6, s[12:15], s62 offen offset:2048 lds
    s_add_u32 m0, s45, 64512
    s_nop 0
    buffer_load_dwordx4 v7, s[12:15], s62 offen lds
    s_add_u32 m0, s45, 64512
    s_nop 0
    buffer_load_dwordx4 v7, s[12:15], s62 offen offset:1024 lds
    s_add_u32 m0, s45, 64512
    s_nop 0
    buffer_load_dwordx4 v7, s[12:15], s62 offen offset:2048 lds
    s_add_u32 m0, s46, 59392
    s_mov_b32 exec_hi, 0
    buffer_load_dwordx4 v8, s[8:11], s61 offen lds
    s_mov_b32 exec_hi, -1
    buffer_load_dwordx4 v[152:155], v9, s[8:11], s66 offen
    buffer_load_dwordx4 v[156:159], v9, s[8:11], s66 offen offset:512
    s_lshl_b32 s48, s24, 2
    s_add_u32 s48, s48, s29
    s_mov_b32 s49, s27
    s_and_b32 s50, s29, 1
    s_lshl_b32 s50, s50, 1
    s_xor_b32 s50, s27, s50
    s_and_b32 s50, s50, 7
    s_and_b32 s54, s50, 3
    s_and_b32 s55, s50, 1
    s_lshl_b32 s53, s32, 2
    s_mul_i32 s58, s32, 14
    s_mov_b32 s72, s64
    s_mov_b32 s73, s65
    s_mov_b32 s74, 524288
    s_mov_b32 s75, 0x20000
    s_mov_b32 s76, s22
    s_mov_b32 s77, s23
    s_mov_b32 s78, 1835008
    s_mov_b32 s79, 0x20000
    v_bfe_u32 v20, v0, 1, 2
    v_lshrrev_b32 v22, 4, v0
    v_xor_b32 v20, v20, v22
    v_lshlrev_b32 v20, 5, v20
    v_lshl_or_b32 v20, v21, 4, v20
    s_lshl_b32 s36, s49, 7
    v_add_u32 v20, s36, v20
    v_lshl_add_u32 v11, v14, 10, v20
    v_lshl_add_u32 v10, v23, 12, v11
    v_add_u32 v9, s44, v1
    v_mov_b32 v16, 0
    v_mov_b32 v17, 0
    v_lshlrev_b32 v20, 2, v0
    v_add_u32 v20, 163328, v20
    ds_write_b32 v20, v16
    v_mov_b32 v21, 163328
    s_lshl_b32 s36, s32, 3
    s_add_u32 s36, s36, 163376
    v_mov_b32 v12, s36
    s_lshl_b32 s36, s32, 2
    s_add_u32 s36, s36, 163344
    v_mov_b32 v13, s36
    s_add_u32 s31, s30, 1
    s_and_b32 s31, s31, 7
    s_lshl_b32 s61, s31, 7
    s_mul_i32 s62, s31, 196608
    s_add_u32 s63, s61, 0x8000
    s_add_u32 m0, s44, 86016
    s_nop 0
    buffer_load_dwordx4 v4, s[8:11], s61 offen lds
    s_add_u32 m0, s45, 104448
    s_nop 0
    buffer_load_dwordx4 v6, s[12:15], s62 offen lds
    s_add_u32 m0, s44, 87040
    s_nop 0
    buffer_load_dwordx4 v5, s[8:11], s61 offen lds
    s_add_u32 m0, s45, 104448
    s_nop 0
    buffer_load_dwordx4 v6, s[12:15], s62 offen offset:1024 lds
    s_add_u32 m0, s44, 88064
    s_nop 0
    buffer_load_dwordx4 v4, s[8:11], s63 offen lds
    s_add_u32 m0, s45, 104448
    s_nop 0
    buffer_load_dwordx4 v6, s[12:15], s62 offen offset:2048 lds
    s_add_u32 m0, s44, 89088
    s_nop 0
    buffer_load_dwordx4 v5, s[8:11], s63 offen lds
    s_add_u32 m0, s45, 107520
    s_nop 0
    buffer_load_dwordx4 v7, s[12:15], s62 offen lds
    s_add_u32 m0, s45, 107520
    s_nop 0
    buffer_load_dwordx4 v7, s[12:15], s62 offen offset:1024 lds
    s_add_u32 m0, s45, 107520
    s_nop 0
    buffer_load_dwordx4 v7, s[12:15], s62 offen offset:2048 lds
    s_add_u32 m0, s46, 102400
    s_mov_b32 exec_hi, 0
    buffer_load_dwordx4 v8, s[8:11], s61 offen lds
    s_mov_b32 exec_hi, -1
    s_lshl_b32 s36, s48, 3
    s_add_u32 s36, s36, s49
    s_lshl_b32 s36, s36, 2
    s_add_u32 s36, s36, s32
    s_lshl_b32 s36, s36, 7
    s_add_u32 s36, s36, 11010048
    s_mov_b64 exec, 1
    buffer_store_dword v16, v16, s[16:19], s36 offen sc1
    s_mov_b64 exec, -1
    s_waitcnt vmcnt(14)
    s_waitcnt lgkmcnt(0)
    s_barrier
    s_waitcnt vmcnt(12)
    s_mov_b32 s36, 0x3f803f80
    v_dot2c_f32_bf16 v16, s36, v152
    v_dot2c_f32_bf16 v17, v152, v152
    v_dot2c_f32_bf16 v16, s36, v153
    v_dot2c_f32_bf16 v17, v153, v153
    v_dot2c_f32_bf16 v16, s36, v154
    v_dot2c_f32_bf16 v17, v154, v154
    v_dot2c_f32_bf16 v16, s36, v155
    v_dot2c_f32_bf16 v17, v155, v155
    v_dot2c_f32_bf16 v16, s36, v156
    v_dot2c_f32_bf16 v17, v156, v156
    v_dot2c_f32_bf16 v16, s36, v157
    v_dot2c_f32_bf16 v17, v157, v157
    v_dot2c_f32_bf16 v16, s36, v158
    v_dot2c_f32_bf16 v17, v158, v158
    v_dot2c_f32_bf16 v16, s36, v159
    v_dot2c_f32_bf16 v17, v159, v159
    s_nop 1
    v_add_f32_dpp v16, v16, v16 quad_perm:[1,0,3,2] row_mask:0xf bank_mask:0xf
    v_add_f32_dpp v17, v17, v17 quad_perm:[1,0,3,2] row_mask:0xf bank_mask:0xf
    s_nop 0
    v_add_f32_dpp v16, v16, v16 quad_perm:[2,3,0,1] row_mask:0xf bank_mask:0xf
    v_add_f32_dpp v17, v17, v17 quad_perm:[2,3,0,1] row_mask:0xf bank_mask:0xf
    s_nop 0
    v_add_f32_dpp v16, v16, v16 row_half_mirror row_mask:0xf bank_mask:0xf
    v_add_f32_dpp v17, v17, v17 row_half_mirror row_mask:0xf bank_mask:0xf
    s_nop 0
    v_add_f32_dpp v16, v16, v16 row_mirror row_mask:0xf bank_mask:0xf
    v_add_f32_dpp v17, v17, v17 row_mirror row_mask:0xf bank_mask:0xf
    v_mov_b32 v18, v16
    v_mov_b32 v19, v17
    s_nop 0
    v_permlane16_swap_b32 v18, v16
    v_permlane16_swap_b32 v19, v17
    v_add_f32 v16, v16, v18
    v_add_f32 v17, v17, v19
    v_mul_f32 v16, 0x3b000000, v16
    v_mul_f32 v17, 0x3b000000, v17
    v_fma_f32 v17, -v16, v16, v17
    v_max_f32 v17, 0, v17
    v_cvt_pk_bf16_f32 v16, v16, v17
    v_and_b32 v17, 0xffff0000, v16
    v_lshlrev_b32 v16, 16, v16
    v_add_f32 v17, 0x3727c5ac, v17
    v_cvt_pk_bf16_f32 v17, v17, v17
    v_and_b32 v17, 0xffff0000, v17
    v_sqrt_f32 v17, v17
    s_nop 0
    v_cvt_pk_bf16_f32 v17, v17, v17
    v_and_b32 v17, 0xffff0000, v17
    v_rcp_f32 v18, v17
    v_sub_f32 v16, 0, v16
    v_mov_b32 v17, v16
    v_mov_b32 v19, v18
    s_lshl_b32 s36, s67, 4
    s_add_u32 s36, s36, 10485760
    v_lshlrev_b32 v22, 4, v23
    s_mov_b32 exec_lo, 1
    s_mov_b32 exec_hi, 1
    buffer_store_dwordx4 v[16:19], v22, s[16:19], s36 offen sc1
    s_mov_b64 exec, -1
    s_add_u32 s31, s30, 2
    s_and_b32 s31, s31, 7
    s_lshl_b32 s61, s31, 7
    s_mul_i32 s62, s31, 196608
    s_add_u32 s63, s61, 0x8000
    s_add_u32 m0, s44, 0
    s_nop 0
    buffer_load_dwordx4 v4, s[8:11], s61 offen lds
    s_add_u32 m0, s45, 18432
    s_nop 0
    buffer_load_dwordx4 v6, s[12:15], s62 offen lds
    s_add_u32 m0, s44, 1024
    s_nop 0
    buffer_load_dwordx4 v5, s[8:11], s61 offen lds
    s_add_u32 m0, s45, 18432
    s_nop 0
    buffer_load_dwordx4 v6, s[12:15], s62 offen offset:1024 lds
    s_add_u32 m0, s44, 2048
    s_nop 0
    buffer_load_dwordx4 v4, s[8:11], s63 offen lds
    s_add_u32 m0, s45, 18432
    s_nop 0
    buffer_load_dwordx4 v6, s[12:15], s62 offen offset:2048 lds
    s_add_u32 m0, s44, 3072
    s_nop 0
    buffer_load_dwordx4 v5, s[8:11], s63 offen lds
    s_add_u32 m0, s45, 21504
    s_nop 0
    buffer_load_dwordx4 v7, s[12:15], s62 offen lds
    s_add_u32 m0, s45, 21504
    s_nop 0
    buffer_load_dwordx4 v7, s[12:15], s62 offen offset:1024 lds
    s_add_u32 m0, s45, 21504
    s_nop 0
    buffer_load_dwordx4 v7, s[12:15], s62 offen offset:2048 lds
    s_add_u32 m0, s46, 16384
    s_mov_b32 exec_hi, 0
    buffer_load_dwordx4 v8, s[8:11], s61 offen lds
    s_mov_b32 exec_hi, -1
    s_waitcnt vmcnt(11)
    s_barrier
    s_cmp_lg_u32 s32, 0
    s_cbranch_scc1 LQ_NOSIG
    s_and_b32 s36, s2, 15
    s_lshl_b32 s36, s36, 4
    v_mov_b32 v20, s36
    v_mov_b32 v22, 1
    s_mov_b64 exec, 1
    global_atomic_add v20, v22, s[70:71] sc1
    s_mov_b64 exec, -1
LQ_NOSIG:
    s_add_u32 s31, s30, 3
    s_and_b32 s31, s31, 7
    s_lshl_b32 s61, s31, 7
    s_mul_i32 s62, s31, 196608
    s_add_u32 s63, s61, 0x8000
    s_add_u32 m0, s44, 43008
    s_nop 0
    buffer_load_dwordx4 v4, s[8:11], s61 offen lds
    s_add_u32 m0, s45, 61440
    s_nop 0
    buffer_load_dwordx4 v6, s[12:15], s62 offen lds
    s_add_u32 m0, s44, 44032
    s_nop 0
    buffer_load_dwordx4 v5, s[8:11], s61 offen lds
    s_add_u32 m0, s45, 61440
    s_nop 0
    buffer_load_dwordx4 v6, s[12:15], s62 offen offset:1024 lds
    s_add_u32 m0, s44, 45056
    s_nop 0
    buffer_load_dwordx4 v4, s[8:11], s63 offen lds
    s_add_u32 m0, s45, 61440
    s_nop 0
    buffer_load_dwordx4 v6, s[12:15], s62 offen offset:2048 lds
    s_add_u32 m0, s44, 46080
    s_nop 0
    buffer_load_dwordx4 v5, s[8:11], s63 offen lds
    s_add_u32 m0, s45, 64512
    s_nop 0
    buffer_load_dwordx4 v7, s[12:15], s62 offen lds
    s_add_u32 m0, s45, 64512
    s_nop 0
    buffer_load_dwordx4 v7, s[12:15], s62 offen offset:1024 lds
    s_add_u32 m0, s45, 64512
    s_nop 0
    buffer_load_dwordx4 v7, s[12:15], s62 offen offset:2048 lds
    s_add_u32 m0, s46, 59392
    s_mov_b32 exec_hi, 0
    buffer_load_dwordx4 v8, s[8:11], s61 offen lds
    s_mov_b32 exec_hi, -1
    s_waitcnt vmcnt(11)
    s_barrier
    s_add_u32 s31, s30, 4
    s_and_b32 s31, s31, 7
    s_lshl_b32 s61, s31, 7
    s_mul_i32 s62, s31, 196608
    s_add_u32 s63, s61, 0x8000
    s_add_u32 m0, s44, 86016
    s_nop 0
    buffer_load_dwordx4 v4, s[8:11], s61 offen lds
    s_add_u32 m0, s45, 104448
    s_nop 0
    buffer_load_dwordx4 v6, s[12:15], s62 offen lds
    s_add_u32 m0, s44, 87040
    s_nop 0
    buffer_load_dwordx4 v5, s[8:11], s61 offen lds
    s_add_u32 m0, s45, 104448
    s_nop 0
    buffer_load_dwordx4 v6, s[12:15], s62 offen offset:1024 lds
    s_add_u32 m0, s44, 88064
    s_nop 0
    buffer_load_dwordx4 v4, s[8:11], s63 offen lds
    s_add_u32 m0, s45, 104448
    s_nop 0
    buffer_load_dwordx4 v6, s[12:15], s62 offen offset:2048 lds
    s_add_u32 m0, s44, 89088
    s_nop 0
    buffer_load_dwordx4 v5, s[8:11], s63 offen lds
    s_add_u32 m0, s45, 107520
    s_nop 0
    buffer_load_dwordx4 v7, s[12:15], s62 offen lds
    s_add_u32 m0, s45, 107520
    s_nop 0
    buffer_load_dwordx4 v7, s[12:15], s62 offen offset:1024 lds
    s_add_u32 m0, s45, 107520
    s_nop 0
    buffer_load_dwordx4 v7, s[12:15], s62 offen offset:2048 lds
    s_add_u32 m0, s46, 102400
    s_mov_b32 exec_hi, 0
    buffer_load_dwordx4 v8, s[8:11], s61 offen lds
    s_mov_b32 exec_hi, -1
    s_waitcnt vmcnt(11)
    s_barrier
    s_add_u32 s31, s30, 5
    s_and_b32 s31, s31, 7
    s_lshl_b32 s61, s31, 7
    s_mul_i32 s62, s31, 196608
    s_add_u32 s63, s61, 0x8000
    s_add_u32 m0, s44, 0
    s_nop 0
    buffer_load_dwordx4 v4, s[8:11], s61 offen lds
    s_add_u32 m0, s45, 18432
    s_nop 0
    buffer_load_dwordx4 v6, s[12:15], s62 offen lds
    s_add_u32 m0, s44, 1024
    s_nop 0
    buffer_load_dwordx4 v5, s[8:11], s61 offen lds
    s_add_u32 m0, s45, 18432
    s_nop 0
    buffer_load_dwordx4 v6, s[12:15], s62 offen offset:1024 lds
    s_add_u32 m0, s44, 2048
    s_nop 0
    buffer_load_dwordx4 v4, s[8:11], s63 offen lds
    s_add_u32 m0, s45, 18432
    s_nop 0
    buffer_load_dwordx4 v6, s[12:15], s62 offen offset:2048 lds
    s_add_u32 m0, s44, 3072
    s_nop 0
    buffer_load_dwordx4 v5, s[8:11], s63 offen lds
    s_add_u32 m0, s45, 21504
    s_nop 0
    buffer_load_dwordx4 v7, s[12:15], s62 offen lds
    s_add_u32 m0, s45, 21504
    s_nop 0
    buffer_load_dwordx4 v7, s[12:15], s62 offen offset:1024 lds
    s_add_u32 m0, s45, 21504
    s_nop 0
    buffer_load_dwordx4 v7, s[12:15], s62 offen offset:2048 lds
    s_add_u32 m0, s46, 16384
    s_mov_b32 exec_hi, 0
    buffer_load_dwordx4 v8, s[8:11], s61 offen lds
    s_mov_b32 exec_hi, -1
    s_lshl_b32 s36, s2, 2
    s_add_u32 s36, s36, s32
    s_mul_i32 s42, s36, 512
    s_mul_i32 s43, s36, 1792
    v_lshlrev_b32 v20, 7, v0
    s_mov_b64 exec, 15
    buffer_load_dword v151, v20, s[72:75], s42 offen
    s_mov_b64 exec, 16383
    buffer_load_dword v151, v20, s[76:79], s43 offen
    s_mov_b64 exec, -1
    s_waitcnt vmcnt(13)
    s_barrier
    s_add_u32 s31, s30, 6
    s_and_b32 s31, s31, 7
    s_lshl_b32 s61, s31, 7
    s_mul_i32 s62, s31, 196608
    s_add_u32 s63, s61, 0x8000
    s_add_u32 m0, s44, 43008
    s_nop 0
    buffer_load_dwordx4 v4, s[8:11], s61 offen lds
    s_add_u32 m0, s45, 61440
    s_nop 0
    buffer_load_dwordx4 v6, s[12:15], s62 offen lds
    s_add_u32 m0, s44, 44032
    s_nop 0
    buffer_load_dwordx4 v5, s[8:11], s61 offen lds
    s_add_u32 m0, s45, 61440
    s_nop 0
    buffer_load_dwordx4 v6, s[12:15], s62 offen offset:1024 lds
    s_add_u32 m0, s44, 45056
    s_nop 0
    buffer_load_dwordx4 v4, s[8:11], s63 offen lds
    s_add_u32 m0, s45, 61440
    s_nop 0
    buffer_load_dwordx4 v6, s[12:15], s62 offen offset:2048 lds
    s_add_u32 m0, s44, 46080
    s_nop 0
    buffer_load_dwordx4 v5, s[8:11], s63 offen lds
    s_add_u32 m0, s45, 64512
    s_nop 0
    buffer_load_dwordx4 v7, s[12:15], s62 offen lds
    s_add_u32 m0, s45, 64512
    s_nop 0
    buffer_load_dwordx4 v7, s[12:15], s62 offen offset:1024 lds
    s_add_u32 m0, s45, 64512
    s_nop 0
    buffer_load_dwordx4 v7, s[12:15], s62 offen offset:2048 lds
    s_add_u32 m0, s46, 59392
    s_mov_b32 exec_hi, 0
    buffer_load_dwordx4 v8, s[8:11], s61 offen lds
    s_mov_b32 exec_hi, -1
    s_waitcnt vmcnt(13)
    s_barrier
    v_and_b32 v2, 0xf0, v1
    global_load_dword v3, v2, s[70:71] sc1
    s_add_u32 s31, s30, 7
    s_and_b32 s31, s31, 7
    s_lshl_b32 s61, s31, 7
    s_mul_i32 s62, s31, 196608
    s_add_u32 s63, s61, 0x8000
    s_add_u32 m0, s44, 86016
    s_nop 0
    buffer_load_dwordx4 v4, s[8:11], s61 offen lds
    s_add_u32 m0, s45, 104448
    s_nop 0
    buffer_load_dwordx4 v6, s[12:15], s62 offen lds
    s_add_u32 m0, s44, 87040
    s_nop 0
    buffer_load_dwordx4 v5, s[8:11], s61 offen lds
    s_add_u32 m0, s45, 104448
    s_nop 0
    buffer_load_dwordx4 v6, s[12:15], s62 offen offset:1024 lds
    s_add_u32 m0, s44, 88064
    s_nop 0
    buffer_load_dwordx4 v4, s[8:11], s63 offen lds
    s_add_u32 m0, s45, 104448
    s_nop 0
    buffer_load_dwordx4 v6, s[12:15], s62 offen offset:2048 lds
    s_add_u32 m0, s44, 89088
    s_nop 0
    buffer_load_dwordx4 v5, s[8:11], s63 offen lds
    s_add_u32 m0, s45, 107520
    s_nop 0
    buffer_load_dwordx4 v7, s[12:15], s62 offen lds
    s_add_u32 m0, s45, 107520
    s_nop 0
    buffer_load_dwordx4 v7, s[12:15], s62 offen offset:1024 lds
    s_add_u32 m0, s45, 107520
    s_nop 0
    buffer_load_dwordx4 v7, s[12:15], s62 offen offset:2048 lds
    s_add_u32 m0, s46, 102400
    s_mov_b32 exec_hi, 0
    buffer_load_dwordx4 v8, s[8:11], s61 offen lds
    s_mov_b32 exec_hi, -1
    s_mul_i32 s36, s32, 36
    v_add_u32 v4, s36, v0
    v_lshlrev_b32 v5, 4, v4
    s_sub_u32 s41, s26, 1
    s_max_i32 s41, s41, 0
    s_sub_u32 s41, s41, s26
    s_lshl_b32 s41, s41, 11
    s_add_u32 s41, s41, 896
    v_and_b32 v14, 0x70, v5
    v_and_b32 v15, 8, v4
    v_lshl_add_u32 v14, v15, 7, v14
    v_add_u32 v14, s41, v14
    v_cmp_gt_u32 vcc, 128, v4
    s_nop 1
    v_cndmask_b32 v14, v14, v5, vcc
    s_lshl_b32 s41, s26, 11
    s_add_u32 s41, s41, 10485760
    v_add_u32 v14, s41, v14
    v_add_u32 v5, 159744, v5
    s_lshl_b32 s42, s28, 14
    s_lshl_b32 s36, s32, 8
    s_add_u32 s42, s42, s36
    s_add_u32 s42, s42, 10616832
    v_lshrrev_b32 v23, 4, v0
    v_lshl_add_u32 v23, v23, 12, v2
    s_add_u32 s36, s36, 162048
    v_add_u32 v15, s36, v2
    s_waitcnt vmcnt(11)
    s_mov_b32 s61, 0
    s_branch LQ_CNT_T
LQ_CNT:
    s_sleep 4
    global_load_dword v3, v2, s[70:71] sc1
    s_add_u32 s61, s61, 1
    s_cmp_ge_u32 s61, 262144
    s_cbranch_scc1 LQ_CNTOK
    s_waitcnt vmcnt(0)
LQ_CNT_T:
    v_cmp_gt_u32 vcc, 16, v3
    s_nop 1
    s_cbranch_vccnz LQ_CNT
LQ_CNTOK:
    s_mov_b32 exec_hi, 15
    buffer_load_dwordx4 v[16:19], v14, s[16:19], 0 offen sc1
    s_mov_b32 exec_hi, -1
    buffer_load_dwordx4 v[152:155], v23, s[16:19], s42 offen offset:0 sc1
    buffer_load_dwordx4 v[156:159], v23, s[16:19], s42 offen offset:1024 sc1
    buffer_load_dwordx4 v[160:163], v23, s[16:19], s42 offen offset:2048 sc1
    buffer_load_dwordx4 v[164:167], v23, s[16:19], s42 offen offset:3072 sc1
    s_barrier
    s_xor_b32 s60, s50, 0
    s_and_b32 s36, s60, 4
    s_add_u32 s60, s60, s36
    s_add_u32 s60, s60, s58
    s_lshl_b32 s60, s60, 15
    s_add_u32 m0, s44, 0
    s_nop 0
    buffer_load_dwordx4 v11, s[76:79], s60 offen lds
    s_add_u32 s63, s60, 8192
    s_add_u32 m0, s44, 1024
    s_nop 0
    buffer_load_dwordx4 v11, s[76:79], s63 offen lds
    s_add_u32 s63, s60, 16384
    s_add_u32 m0, s44, 2048
    s_nop 0
    buffer_load_dwordx4 v11, s[76:79], s63 offen lds
    s_add_u32 s63, s60, 24576
    s_add_u32 m0, s44, 3072
    s_nop 0
    buffer_load_dwordx4 v11, s[76:79], s63 offen lds
    s_waitcnt vmcnt(9)
    v_mov_b32 v22, 1
    s_mov_b64 exec, 1
    ds_add_u32 v21, v22 offset:192
    s_mov_b64 exec, -1
    s_waitcnt vmcnt(8)
    s_mov_b32 exec_hi, 15
    ds_write_b128 v5, v[16:19]
    v_lshlrev_b32 v4, 2, v4
    v_add_u32 v4, 147456, v4
    ds_write_b32 v4, v16
    ds_write_b32 v4, v18 offset:576
    s_mov_b32 exec_hi, -1
    s_waitcnt vmcnt(4)
    v_add_f32 v152, v152, v156
    v_add_f32 v160, v160, v164
    v_add_f32 v153, v153, v157
    v_add_f32 v161, v161, v165
    v_add_f32 v154, v154, v158
    v_add_f32 v162, v162, v166
    v_add_f32 v155, v155, v159
    v_add_f32 v163, v163, v167
    v_add_f32 v152, v152, v160
    v_add_f32 v153, v153, v161
    v_add_f32 v154, v154, v162
    v_add_f32 v155, v155, v163
    v_mov_b32 v156, v152
    v_mov_b32 v157, v153
    v_mov_b32 v158, v154
    v_mov_b32 v159, v155
    v_permlane32_swap_b32 v156, v152
    v_permlane32_swap_b32 v157, v153
    v_permlane32_swap_b32 v158, v154
    v_permlane32_swap_b32 v159, v155
    v_add_f32 v152, v152, v156
    v_add_f32 v153, v153, v157
    v_add_f32 v154, v154, v158
    v_add_f32 v155, v155, v159
    v_mov_b32 v156, v152
    v_mov_b32 v157, v153
    v_mov_b32 v158, v154
    v_mov_b32 v159, v155
    v_permlane16_swap_b32 v156, v152
    v_permlane16_swap_b32 v157, v153
    v_permlane16_swap_b32 v158, v154
    v_permlane16_swap_b32 v159, v155
    v_add_f32 v152, v152, v156
    v_add_f32 v153, v153, v157
    v_add_f32 v154, v154, v158
    v_add_f32 v155, v155, v159
    ds_write_b128 v15, v[152:155]
    v_mov_b32 v22, 1
    s_mov_b64 exec, 1
    ds_add_u32 v21, v22 offset:8
    s_mov_b64 exec, -1
    s_lshl_b32 s41, s48, 3
    s_add_u32 s41, s41, s49
    s_lshl_b32 s41, s41, 2
    s_add_u32 s41, s41, s32
    s_lshl_b32 s41, s41, 7
    s_add_u32 s41, s41, 11010048
    s_and_b32 s36, s48, 1
    s_lshl_b32 s56, 0x50500000, s36
    s_lshl_b32 s62, 0x05050000, s36
    s_lshl_b32 s36, s36, 2
    s_lshl_b32 s42, 0x0f0f, s36
    s_and_b32 s36, s50, 4
    s_lshl_b32 s36, s36, 1
    s_lshl_b32 s43, 0xff0000, s36
    s_or_b32 s46, s42, s62
    s_and_b32 s43, s43, s62
    s_xor_b32 s62, s62, s43
    s_or_b32 s46, s46, s56
    v_and_b32 v4, 15, v0
    v_lshlrev_b32 v4, 7, v4
    v_lshrrev_b32 v5, 4, v0
    v_lshl_add_u32 v4, v5, 2, v4
    s_mov_b32 s98, 0
    v_mov_b32 v2, 0
    v_mov_b32 v3, 0
    v_mov_b32 v5, 0
    s_xor_b32 s60, s50, 1
    s_and_b32 s36, s60, 4
    s_add_u32 s60, s60, s36
    s_add_u32 s60, s60, s58
    s_lshl_b32 s60, s60, 15
    s_add_u32 m0, s44, 16384
    s_nop 0
    buffer_load_dwordx4 v11, s[76:79], s60 offen lds
    s_add_u32 s63, s60, 8192
    s_add_u32 m0, s44, 17408
    s_nop 0
    buffer_load_dwordx4 v11, s[76:79], s63 offen lds
    s_add_u32 s63, s60, 16384
    s_add_u32 m0, s44, 18432
    s_nop 0
    buffer_load_dwordx4 v11, s[76:79], s63 offen lds
    s_add_u32 s63, s60, 24576
    s_add_u32 m0, s44, 19456
    s_nop 0
    buffer_load_dwordx4 v11, s[76:79], s63 offen lds
    s_xor_b32 s60, s54, 0
    s_add_u32 s60, s60, s53
    s_lshl_b32 s60, s60, 15
    s_add_u32 m0, s44, 131072
    s_nop 0
    buffer_load_dwordx4 v10, s[72:75], s60 offen lds
    s_add_u32 s63, s60, 16384
    s_add_u32 m0, s44, 132096
    s_nop 0
    buffer_load_dwordx4 v10, s[72:75], s63 offen lds
    s_add_u32 s63, s60, 4096
    s_add_u32 m0, s44, 133120
    s_nop 0
    buffer_load_dwordx4 v10, s[72:75], s63 offen lds
    s_add_u32 s63, s60, 20480
    s_add_u32 m0, s44, 134144
    s_nop 0
    buffer_load_dwordx4 v10, s[72:75], s63 offen lds
    s_xor_b32 s60, s50, 5
    s_and_b32 s36, s60, 4
    s_add_u32 s60, s60, s36
    s_add_u32 s60, s60, s58
    s_lshl_b32 s60, s60, 15
    buffer_load_dwordx4 v[24:27], v11, s[76:79], s60 offen
    s_add_u32 s63, s60, 8192
    buffer_load_dwordx4 v[28:31], v11, s[76:79], s63 offen
    s_add_u32 s63, s60, 16384
    buffer_load_dwordx4 v[32:35], v11, s[76:79], s63 offen
    s_add_u32 s63, s60, 24576
    buffer_load_dwordx4 v[36:39], v11, s[76:79], s63 offen
    s_xor_b32 s60, s50, 6
    s_and_b32 s36, s60, 4
    s_add_u32 s60, s60, s36
    s_add_u32 s60, s60, s58
    s_lshl_b32 s60, s60, 15
    buffer_load_dwordx4 v[40:43], v11, s[76:79], s60 offen
    s_add_u32 s63, s60, 8192
    buffer_load_dwordx4 v[44:47], v11, s[76:79], s63 offen
    s_add_u32 s63, s60, 16384
    buffer_load_dwordx4 v[48:51], v11, s[76:79], s63 offen
    s_add_u32 s63, s60, 24576
    buffer_load_dwordx4 v[52:55], v11, s[76:79], s63 offen
    s_xor_b32 s60, s50, 7
    s_and_b32 s36, s60, 4
    s_add_u32 s60, s60, s36
    s_add_u32 s60, s60, s58
    s_lshl_b32 s60, s60, 15
    buffer_load_dwordx4 v[56:59], v11, s[76:79], s60 offen
    s_add_u32 s63, s60, 8192
    buffer_load_dwordx4 v[60:63], v11, s[76:79], s63 offen
    s_add_u32 s63, s60, 16384
    buffer_load_dwordx4 v[64:67], v11, s[76:79], s63 offen
    s_add_u32 s63, s60, 24576
    buffer_load_dwordx4 v[68:71], v11, s[76:79], s63 offen
    ds_read_b32 v22, v21 offset:120
    s_waitcnt lgkmcnt(0)
    v_readfirstlane_b32 s36, v22
    s_nop 0
    s_cmp_lt_u32 s36, 8
    s_cbranch_scc0 LQ_SV1_OK
    s_mov_b32 s99, 0
LQ_SV1:
    s_sleep 1
    s_add_u32 s99, s99, 1
    s_cmp_ge_u32 s99, 262144
    s_cbranch_scc1 LQ_SV1_OK
    ds_read_b32 v22, v21 offset:120
    s_waitcnt lgkmcnt(0)
    v_readfirstlane_b32 s36, v22
    s_nop 0
    s_cmp_lt_u32 s36, 8
    s_cbranch_scc1 LQ_SV1
LQ_SV1_OK:
    s_xor_b32 s60, s50, 2
    s_and_b32 s36, s60, 4
    s_add_u32 s60, s60, s36
    s_add_u32 s60, s60, s58
    s_lshl_b32 s60, s60, 15
    s_add_u32 m0, s44, 32768
    s_nop 0
    buffer_load_dwordx4 v11, s[76:79], s60 offen lds
    s_add_u32 s63, s60, 8192
    s_add_u32 m0, s44, 33792
    s_nop 0
    buffer_load_dwordx4 v11, s[76:79], s63 offen lds
    s_add_u32 s63, s60, 16384
    s_add_u32 m0, s44, 34816
    s_nop 0
    buffer_load_dwordx4 v11, s[76:79], s63 offen lds
    s_add_u32 s63, s60, 24576
    s_add_u32 m0, s44, 35840
    s_nop 0
    buffer_load_dwordx4 v11, s[76:79], s63 offen lds
    s_xor_b32 s60, s50, 3
    s_and_b32 s36, s60, 4
    s_add_u32 s60, s60, s36
    s_add_u32 s60, s60, s58
    s_lshl_b32 s60, s60, 15
    s_add_u32 m0, s44, 49152
    s_nop 0
    buffer_load_dwordx4 v11, s[76:79], s60 offen lds
    s_add_u32 s63, s60, 8192
    s_add_u32 m0, s44, 50176
    s_nop 0
    buffer_load_dwordx4 v11, s[76:79], s63 offen lds
    s_add_u32 s63, s60, 16384
    s_add_u32 m0, s44, 51200
    s_nop 0
    buffer_load_dwordx4 v11, s[76:79], s63 offen lds
    s_add_u32 s63, s60, 24576
    s_add_u32 m0, s44, 52224
    s_nop 0
    buffer_load_dwordx4 v11, s[76:79], s63 offen lds
    s_xor_b32 s60, s50, 4
    s_and_b32 s36, s60, 4
    s_add_u32 s60, s60, s36
    s_add_u32 s60, s60, s58
    s_lshl_b32 s60, s60, 15
    s_add_u32 m0, s44, 65536
    s_nop 0
    buffer_load_dwordx4 v11, s[76:79], s60 offen lds
    s_add_u32 s63, s60, 8192
    s_add_u32 m0, s44, 66560
    s_nop 0
    buffer_load_dwordx4 v11, s[76:79], s63 offen lds
    s_add_u32 s63, s60, 16384
    s_add_u32 m0, s44, 67584
    s_nop 0
    buffer_load_dwordx4 v11, s[76:79], s63 offen lds
    s_add_u32 s63, s60, 24576
    s_add_u32 m0, s44, 68608
    s_nop 0
    buffer_load_dwordx4 v11, s[76:79], s63 offen lds
    s_xor_b32 s60, s54, 1
    s_add_u32 s60, s60, s53
    s_lshl_b32 s60, s60, 15
    buffer_load_dwordx4 v[72:75], v10, s[72:75], s60 offen
    s_add_u32 s63, s60, 16384
    buffer_load_dwordx4 v[76:79], v10, s[72:75], s63 offen
    s_add_u32 s63, s60, 4096
    buffer_load_dwordx4 v[80:83], v10, s[72:75], s63 offen
    s_add_u32 s63, s60, 20480
    buffer_load_dwordx4 v[84:87], v10, s[72:75], s63 offen
    s_xor_b32 s60, s54, 2
    s_add_u32 s60, s60, s53
    s_lshl_b32 s60, s60, 15
    buffer_load_dwordx4 v[88:91], v10, s[72:75], s60 offen
    s_add_u32 s63, s60, 16384
    buffer_load_dwordx4 v[92:95], v10, s[72:75], s63 offen
    s_add_u32 s63, s60, 4096
    buffer_load_dwordx4 v[96:99], v10, s[72:75], s63 offen
    s_add_u32 s63, s60, 20480
    buffer_load_dwordx4 v[100:103], v10, s[72:75], s63 offen
    s_waitcnt vmcnt(8)
    v_mov_b32 v22, 5
    ds_write_b32 v13, v22
    ds_read_b32 v22, v21 offset:124
    s_waitcnt lgkmcnt(0)
    v_readfirstlane_b32 s36, v22
    s_nop 0
    s_cmp_lt_u32 s36, 8
    s_cbranch_scc0 LQ_SV2_OK
    s_mov_b32 s99, 0
LQ_SV2:
    s_sleep 1
    s_add_u32 s99, s99, 1
    s_cmp_ge_u32 s99, 262144
    s_cbranch_scc1 LQ_SV2_OK
    ds_read_b32 v22, v21 offset:124
    s_waitcnt lgkmcnt(0)
    v_readfirstlane_b32 s36, v22
    s_nop 0
    s_cmp_lt_u32 s36, 8
    s_cbranch_scc1 LQ_SV2
LQ_SV2_OK:
    v_add_u32 v20, 81920, v9
    ds_write_b128 v20, v[24:27] offset:0
    ds_write_b128 v20, v[28:31] offset:1024
    ds_write_b128 v20, v[32:35] offset:2048
    ds_write_b128 v20, v[36:39] offset:3072
    v_add_u32 v20, 98304, v9
    ds_write_b128 v20, v[40:43] offset:0
    ds_write_b128 v20, v[44:47] offset:1024
    ds_write_b128 v20, v[48:51] offset:2048
    ds_write_b128 v20, v[52:55] offset:3072
    v_add_u32 v20, 114688, v9
    ds_write_b128 v20, v[56:59] offset:0
    ds_write_b128 v20, v[60:63] offset:1024
    ds_write_b128 v20, v[64:67] offset:2048
    ds_write_b128 v20, v[68:71] offset:3072
    v_mov_b32 v22, 9
    ds_write_b32 v13, v22
    s_waitcnt lgkmcnt(0)
    ds_read_b64 v[16:17], v12
    s_waitcnt lgkmcnt(0)
    v_min_u32 v16, v16, v17
    s_nop 0
    v_readfirstlane_b32 s36, v16
    s_nop 0
    s_cmp_lt_u32 s36, 1
    s_cbranch_scc0 LQ_SV3_OK
    s_mov_b32 s99, 0
LQ_SV3:
    s_sleep 1
    s_add_u32 s99, s99, 1
    s_cmp_ge_u32 s99, 262144
    s_cbranch_scc1 LQ_SV3_OK
    ds_read_b64 v[16:17], v12
    s_waitcnt lgkmcnt(0)
    v_min_u32 v16, v16, v17
    s_nop 0
    v_readfirstlane_b32 s36, v16
    s_nop 0
    s_cmp_lt_u32 s36, 1
    s_cbranch_scc1 LQ_SV3
LQ_SV3_OK:
    s_waitcnt vmcnt(4)
    v_add_u32 v20, 0, v9
    ds_write_b128 v20, v[72:75] offset:0
    ds_write_b128 v20, v[76:79] offset:1024
    ds_write_b128 v20, v[80:83] offset:2048
    ds_write_b128 v20, v[84:87] offset:3072
    v_mov_b32 v22, 10
    ds_write_b32 v13, v22
    ds_read_b64 v[16:17], v12
    s_waitcnt lgkmcnt(0)
    v_min_u32 v16, v16, v17
    s_nop 0
    v_readfirstlane_b32 s36, v16
    s_nop 0
    s_cmp_lt_u32 s36, 2
    s_cbranch_scc0 LQ_SV4_OK
    s_mov_b32 s99, 0
LQ_SV4:
    s_cmp_eq_u32 s98, s46
    s_cbranch_scc1 LQ_SV4_NP
    s_load_dword s98, s[16:17], s41 glc
    s_waitcnt lgkmcnt(0)
    s_and_b32 s98, s98, s46
    v_mov_b32 v14, s98
    ds_write_b32 v13, v14 offset:16
LQ_SV4_NP:
    s_sleep 1
    s_add_u32 s99, s99, 1
    s_cmp_ge_u32 s99, 262144
    s_cbranch_scc1 LQ_SV4_OK
    ds_read_b64 v[16:17], v12
    s_waitcnt lgkmcnt(0)
    v_min_u32 v16, v16, v17
    s_nop 0
    v_readfirstlane_b32 s36, v16
    s_nop 0
    s_cmp_lt_u32 s36, 2
    s_cbranch_scc1 LQ_SV4
LQ_SV4_OK:
    s_waitcnt vmcnt(0)
    v_add_u32 v20, 16384, v9
    ds_write_b128 v20, v[88:91] offset:0
    ds_write_b128 v20, v[92:95] offset:1024
    ds_write_b128 v20, v[96:99] offset:2048
    ds_write_b128 v20, v[100:103] offset:3072
    v_mov_b32 v22, 11
    ds_write_b32 v13, v22
    ds_read_b64 v[16:17], v12
    s_waitcnt lgkmcnt(0)
    v_min_u32 v16, v16, v17
    s_nop 0
    v_readfirstlane_b32 s36, v16
    s_nop 0
    s_cmp_lt_u32 s36, 3
    s_cbranch_scc0 LQ_SV5_OK
    s_mov_b32 s99, 0
LQ_SV5:
    s_cmp_eq_u32 s98, s46
    s_cbranch_scc1 LQ_SV5_NP
    s_load_dword s98, s[16:17], s41 glc
    s_waitcnt lgkmcnt(0)
    s_and_b32 s98, s98, s46
    v_mov_b32 v14, s98
    ds_write_b32 v13, v14 offset:16
LQ_SV5_NP:
    s_sleep 1
    s_add_u32 s99, s99, 1
    s_cmp_ge_u32 s99, 262144
    s_cbranch_scc1 LQ_SV5_OK
    ds_read_b64 v[16:17], v12
    s_waitcnt lgkmcnt(0)
    v_min_u32 v16, v16, v17
    s_nop 0
    v_readfirstlane_b32 s36, v16
    s_nop 0
    s_cmp_lt_u32 s36, 3
    s_cbranch_scc1 LQ_SV5
LQ_SV5_OK:
    s_xor_b32 s60, s54, 3
    s_add_u32 s60, s60, s53
    s_lshl_b32 s60, s60, 15
    s_add_u32 m0, s44, 32768
    s_nop 0
    buffer_load_dwordx4 v10, s[72:75], s60 offen lds
    s_add_u32 s63, s60, 16384
    s_add_u32 m0, s44, 33792
    s_nop 0
    buffer_load_dwordx4 v10, s[72:75], s63 offen lds
    s_add_u32 s63, s60, 4096
    s_add_u32 m0, s44, 34816
    s_nop 0
    buffer_load_dwordx4 v10, s[72:75], s63 offen lds
    s_add_u32 s63, s60, 20480
    s_add_u32 m0, s44, 35840
    s_nop 0
    buffer_load_dwordx4 v10, s[72:75], s63 offen lds
    ds_read_b64 v[16:17], v12
    s_waitcnt lgkmcnt(0)
    v_min_u32 v16, v16, v17
    s_nop 0
    v_readfirstlane_b32 s36, v16
    s_nop 0
    s_cmp_lt_u32 s36, 4
    s_cbranch_scc0 LQ_SV6_OK
    s_mov_b32 s99, 0
    s_waitcnt vmcnt(0)
    v_mov_b32 v22, 12
    ds_write_b32 v13, v22
LQ_SV6:
    s_cmp_eq_u32 s98, s46
    s_cbranch_scc1 LQ_SV6_NP
    s_load_dword s98, s[16:17], s41 glc
    s_waitcnt lgkmcnt(0)
    s_and_b32 s98, s98, s46
    v_mov_b32 v14, s98
    ds_write_b32 v13, v14 offset:16
LQ_SV6_NP:
    s_sleep 1
    s_add_u32 s99, s99, 1
    s_cmp_ge_u32 s99, 262144
    s_cbranch_scc1 LQ_SV6_OK
    ds_read_b64 v[16:17], v12
    s_waitcnt lgkmcnt(0)
    v_min_u32 v16, v16, v17
    s_nop 0
    v_readfirstlane_b32 s36, v16
    s_nop 0
    s_cmp_lt_u32 s36, 4
    s_cbranch_scc1 LQ_SV6
LQ_SV6_OK:
    s_xor_b32 s60, s54, 0
    s_and_b32 s36, s60, 2
    s_mul_i32 s36, s36, 3
    s_add_u32 s60, s60, s36
    s_add_u32 s60, s60, s58
    s_add_u32 s60, s60, 4
    s_lshl_b32 s60, s60, 15
    s_add_u32 m0, s44, 49152
    s_nop 0
    buffer_load_dwordx4 v11, s[76:79], s60 offen lds
    s_add_u32 s63, s60, 8192
    s_add_u32 m0, s44, 50176
    s_nop 0
    buffer_load_dwordx4 v11, s[76:79], s63 offen lds
    s_add_u32 s63, s60, 16384
    s_add_u32 m0, s44, 51200
    s_nop 0
    buffer_load_dwordx4 v11, s[76:79], s63 offen lds
    s_add_u32 s63, s60, 24576
    s_add_u32 m0, s44, 52224
    s_nop 0
    buffer_load_dwordx4 v11, s[76:79], s63 offen lds
    ds_read_b64 v[16:17], v12
    s_waitcnt lgkmcnt(0)
    v_min_u32 v16, v16, v17
    s_nop 0
    v_readfirstlane_b32 s36, v16
    s_nop 0
    s_cmp_lt_u32 s36, 5
    s_cbranch_scc0 LQ_SV7_OK
    s_mov_b32 s99, 0
    s_waitcnt vmcnt(0)
    v_mov_b32 v22, 13
    ds_write_b32 v13, v22
LQ_SV7:
    s_cmp_eq_u32 s98, s46
    s_cbranch_scc1 LQ_SV7_NP
    s_load_dword s98, s[16:17], s41 glc
    s_waitcnt lgkmcnt(0)
    s_and_b32 s98, s98, s46
    v_mov_b32 v14, s98
    ds_write_b32 v13, v14 offset:16
LQ_SV7_NP:
    s_sleep 1
    s_add_u32 s99, s99, 1
    s_cmp_ge_u32 s99, 262144
    s_cbranch_scc1 LQ_SV7_OK
    ds_read_b64 v[16:17], v12
    s_waitcnt lgkmcnt(0)
    v_min_u32 v16, v16, v17
    s_nop 0
    v_readfirstlane_b32 s36, v16
    s_nop 0
    s_cmp_lt_u32 s36, 5
    s_cbranch_scc1 LQ_SV7
LQ_SV7_OK:
    s_xor_b32 s60, s54, 1
    s_and_b32 s36, s60, 2
    s_mul_i32 s36, s36, 3
    s_add_u32 s60, s60, s36
    s_add_u32 s60, s60, s58
    s_add_u32 s60, s60, 4
    s_lshl_b32 s60, s60, 15
    s_add_u32 m0, s44, 65536
    s_nop 0
    buffer_load_dwordx4 v11, s[76:79], s60 offen lds
    s_add_u32 s63, s60, 8192
    s_add_u32 m0, s44, 66560
    s_nop 0
    buffer_load_dwordx4 v11, s[76:79], s63 offen lds
    s_add_u32 s63, s60, 16384
    s_add_u32 m0, s44, 67584
    s_nop 0
    buffer_load_dwordx4 v11, s[76:79], s63 offen lds
    s_add_u32 s63, s60, 24576
    s_add_u32 m0, s44, 68608
    s_nop 0
    buffer_load_dwordx4 v11, s[76:79], s63 offen lds
    s_waitcnt vmcnt(8)
    v_mov_b32 v22, 12
    s_mov_b64 exec, 1
    ds_max_u32 v13, v22
    s_mov_b64 exec, -1
    ds_read_b64 v[16:17], v12
    s_waitcnt lgkmcnt(0)
    v_min_u32 v16, v16, v17
    s_nop 0
    v_readfirstlane_b32 s36, v16
    s_nop 0
    s_cmp_lt_u32 s36, 6
    s_cbranch_scc0 LQ_SV8_OK
    s_mov_b32 s99, 0
    s_waitcnt vmcnt(0)
    v_mov_b32 v22, 14
    ds_write_b32 v13, v22
LQ_SV8:
    s_cmp_eq_u32 s98, s46
    s_cbranch_scc1 LQ_SV8_NP
    s_load_dword s98, s[16:17], s41 glc
    s_waitcnt lgkmcnt(0)
    s_and_b32 s98, s98, s46
    v_mov_b32 v14, s98
    ds_write_b32 v13, v14 offset:16
LQ_SV8_NP:
    s_sleep 1
    s_add_u32 s99, s99, 1
    s_cmp_ge_u32 s99, 262144
    s_cbranch_scc1 LQ_SV8_OK
    ds_read_b64 v[16:17], v12
    s_waitcnt lgkmcnt(0)
    v_min_u32 v16, v16, v17
    s_nop 0
    v_readfirstlane_b32 s36, v16
    s_nop 0
    s_cmp_lt_u32 s36, 6
    s_cbranch_scc1 LQ_SV8
LQ_SV8_OK:
    s_xor_b32 s60, s54, 2
    s_and_b32 s36, s60, 2
    s_mul_i32 s36, s36, 3
    s_add_u32 s60, s60, s36
    s_add_u32 s60, s60, s58
    s_add_u32 s60, s60, 4
    s_lshl_b32 s60, s60, 15
    s_add_u32 m0, s44, 81920
    s_nop 0
    buffer_load_dwordx4 v11, s[76:79], s60 offen lds
    s_add_u32 s63, s60, 8192
    s_add_u32 m0, s44, 82944
    s_nop 0
    buffer_load_dwordx4 v11, s[76:79], s63 offen lds
    s_add_u32 s63, s60, 16384
    s_add_u32 m0, s44, 83968
    s_nop 0
    buffer_load_dwordx4 v11, s[76:79], s63 offen lds
    s_add_u32 s63, s60, 24576
    s_add_u32 m0, s44, 84992
    s_nop 0
    buffer_load_dwordx4 v11, s[76:79], s63 offen lds
    s_waitcnt vmcnt(8)
    v_mov_b32 v22, 13
    s_mov_b64 exec, 1
    ds_max_u32 v13, v22
    s_mov_b64 exec, -1
    ds_read_b64 v[16:17], v12
    s_waitcnt lgkmcnt(0)
    v_min_u32 v16, v16, v17
    s_nop 0
    v_readfirstlane_b32 s36, v16
    s_nop 0
    s_cmp_lt_u32 s36, 7
    s_cbranch_scc0 LQ_SV9_OK
    s_mov_b32 s99, 0
    s_waitcnt vmcnt(0)
    v_mov_b32 v22, 15
    ds_write_b32 v13, v22
LQ_SV9:
    s_cmp_eq_u32 s98, s46
    s_cbranch_scc1 LQ_SV9_NP
    s_load_dword s98, s[16:17], s41 glc
    s_waitcnt lgkmcnt(0)
    s_and_b32 s98, s98, s46
    v_mov_b32 v14, s98
    ds_write_b32 v13, v14 offset:16
LQ_SV9_NP:
    s_sleep 1
    s_add_u32 s99, s99, 1
    s_cmp_ge_u32 s99, 262144
    s_cbranch_scc1 LQ_SV9_OK
    ds_read_b64 v[16:17], v12
    s_waitcnt lgkmcnt(0)
    v_min_u32 v16, v16, v17
    s_nop 0
    v_readfirstlane_b32 s36, v16
    s_nop 0
    s_cmp_lt_u32 s36, 7
    s_cbranch_scc1 LQ_SV9
LQ_SV9_OK:
    s_xor_b32 s60, s54, 3
    s_and_b32 s36, s60, 2
    s_mul_i32 s36, s36, 3
    s_add_u32 s60, s60, s36
    s_add_u32 s60, s60, s58
    s_add_u32 s60, s60, 4
    s_lshl_b32 s60, s60, 15
    s_add_u32 m0, s44, 98304
    s_nop 0
    buffer_load_dwordx4 v11, s[76:79], s60 offen lds
    s_add_u32 s63, s60, 8192
    s_add_u32 m0, s44, 99328
    s_nop 0
    buffer_load_dwordx4 v11, s[76:79], s63 offen lds
    s_add_u32 s63, s60, 16384
    s_add_u32 m0, s44, 100352
    s_nop 0
    buffer_load_dwordx4 v11, s[76:79], s63 offen lds
    s_add_u32 s63, s60, 24576
    s_add_u32 m0, s44, 101376
    s_nop 0
    buffer_load_dwordx4 v11, s[76:79], s63 offen lds
    s_waitcnt vmcnt(8)
    v_mov_b32 v22, 14
    s_mov_b64 exec, 1
    ds_max_u32 v13, v22
    s_mov_b64 exec, -1
    ds_read_b64 v[16:17], v12
    s_waitcnt lgkmcnt(0)
    v_min_u32 v16, v16, v17
    s_nop 0
    v_readfirstlane_b32 s36, v16
    s_nop 0
    s_cmp_lt_u32 s36, 8
    s_cbranch_scc0 LQ_SV10_OK
    s_mov_b32 s99, 0
    s_waitcnt vmcnt(0)
    v_mov_b32 v22, 16
    ds_write_b32 v13, v22
LQ_SV10:
    s_cmp_eq_u32 s98, s46
    s_cbranch_scc1 LQ_SV10_NP
    s_load_dword s98, s[16:17], s41 glc
    s_waitcnt lgkmcnt(0)
    s_and_b32 s98, s98, s46
    v_mov_b32 v14, s98
    ds_write_b32 v13, v14 offset:16
LQ_SV10_NP:
    s_sleep 1
    s_add_u32 s99, s99, 1
    s_cmp_ge_u32 s99, 262144
    s_cbranch_scc1 LQ_SV10_OK
    ds_read_b64 v[16:17], v12
    s_waitcnt lgkmcnt(0)
    v_min_u32 v16, v16, v17
    s_nop 0
    v_readfirstlane_b32 s36, v16
    s_nop 0
    s_cmp_lt_u32 s36, 8
    s_cbranch_scc1 LQ_SV10
LQ_SV10_OK:
    s_xor_b32 s60, s55, 0
    s_add_u32 s60, s60, s58
    s_add_u32 s60, s60, 6
    s_lshl_b32 s60, s60, 15
    s_add_u32 m0, s44, 114688
    s_nop 0
    buffer_load_dwordx4 v10, s[76:79], s60 offen lds
    s_add_u32 s63, s60, 16384
    s_add_u32 m0, s44, 115712
    s_nop 0
    buffer_load_dwordx4 v10, s[76:79], s63 offen lds
    s_add_u32 s63, s60, 4096
    s_add_u32 m0, s44, 116736
    s_nop 0
    buffer_load_dwordx4 v10, s[76:79], s63 offen lds
    s_add_u32 s63, s60, 20480
    s_add_u32 m0, s44, 117760
    s_nop 0
    buffer_load_dwordx4 v10, s[76:79], s63 offen lds
    s_waitcnt vmcnt(8)
    v_mov_b32 v22, 15
    s_mov_b64 exec, 1
    ds_max_u32 v13, v22
    s_mov_b64 exec, -1
    ds_read_b64 v[16:17], v12
    s_waitcnt lgkmcnt(0)
    v_min_u32 v16, v16, v17
    s_nop 0
    v_readfirstlane_b32 s36, v16
    s_nop 0
    s_cmp_lt_u32 s36, 9
    s_cbranch_scc0 LQ_SV11_OK
    s_mov_b32 s99, 0
    s_waitcnt vmcnt(0)
    v_mov_b32 v22, 17
    ds_write_b32 v13, v22
LQ_SV11:
    s_cmp_eq_u32 s98, s46
    s_cbranch_scc1 LQ_SV11_NP
    s_load_dword s98, s[16:17], s41 glc
    s_waitcnt lgkmcnt(0)
    s_and_b32 s98, s98, s46
    v_mov_b32 v14, s98
    ds_write_b32 v13, v14 offset:16
LQ_SV11_NP:
    s_sleep 1
    s_add_u32 s99, s99, 1
    s_cmp_ge_u32 s99, 262144
    s_cbranch_scc1 LQ_SV11_OK
    ds_read_b64 v[16:17], v12
    s_waitcnt lgkmcnt(0)
    v_min_u32 v16, v16, v17
    s_nop 0
    v_readfirstlane_b32 s36, v16
    s_nop 0
    s_cmp_lt_u32 s36, 9
    s_cbranch_scc1 LQ_SV11
LQ_SV11_OK:
    s_xor_b32 s60, s55, 1
    s_add_u32 s60, s60, s58
    s_add_u32 s60, s60, 6
    s_lshl_b32 s60, s60, 15
    s_add_u32 m0, s44, 131072
    s_nop 0
    buffer_load_dwordx4 v10, s[76:79], s60 offen lds
    s_add_u32 s63, s60, 16384
    s_add_u32 m0, s44, 132096
    s_nop 0
    buffer_load_dwordx4 v10, s[76:79], s63 offen lds
    s_add_u32 s63, s60, 4096
    s_add_u32 m0, s44, 133120
    s_nop 0
    buffer_load_dwordx4 v10, s[76:79], s63 offen lds
    s_add_u32 s63, s60, 20480
    s_add_u32 m0, s44, 134144
    s_nop 0
    buffer_load_dwordx4 v10, s[76:79], s63 offen lds
    s_waitcnt vmcnt(8)
    v_mov_b32 v22, 16
    s_mov_b64 exec, 1
    ds_max_u32 v13, v22
    s_mov_b64 exec, -1
    s_waitcnt vmcnt(4)
    v_mov_b32 v22, 17
    s_mov_b64 exec, 1
    ds_max_u32 v13, v22
    s_mov_b64 exec, -1
    s_waitcnt vmcnt(0)
    v_mov_b32 v22, 18
    s_mov_b64 exec, 1
    ds_max_u32 v13, v22
    s_mov_b64 exec, -1
    s_cmp_lg_u32 s98, s46
    s_cbranch_scc0 LQ_SV12_OK
    s_mov_b32 s99, 0
LQ_SV12:
    s_cmp_eq_u32 s98, s46
    s_cbranch_scc1 LQ_SV12_NP
    s_load_dword s98, s[16:17], s41 glc
    s_waitcnt lgkmcnt(0)
    s_and_b32 s98, s98, s46
    v_mov_b32 v14, s98
    ds_write_b32 v13, v14 offset:16
LQ_SV12_NP:
    s_sleep 1
    s_add_u32 s99, s99, 1
    s_cmp_ge_u32 s99, 262144
    s_cbranch_scc1 LQ_SV12_OK
    s_cmp_lg_u32 s98, s46
    s_cbranch_scc1 LQ_SV12
LQ_SV12_OK:
    s_waitcnt lgkmcnt(0)
    s_endpgm
L_COMPUTE:
    s_lshr_b32 s31, s3, 2
    s_and_b32 s35, s3, 1
    s_mov_b32 s40, 0x3f803f80
    v_and_b32 v2, 15, v0
    v_lshrrev_b32 v3, 4, v0
    v_bfe_u32 v47, v0, 2, 2
    v_and_b32 v48, 3, v0
    v_lshrrev_b32 v44, 1, v2
    v_xor_b32 v44, v3, v44
    v_lshlrev_b32 v44, 4, v44
    v_lshl_or_b32 v44, v2, 7, v44
    v_lshrrev_b32 v45, 1, v47
    v_and_b32 v49, 1, v3
    v_lshl_or_b32 v45, v49, 1, v45
    v_lshlrev_b32 v46, 7, v47
    v_lshl_add_u32 v46, v48, 3, v46
    s_lshl_b32 s66, s26, 13
    s_and_b32 s36, s28, 6
    s_lshl_b32 s36, s36, 6
    s_add_u32 s66, s66, s36
    s_add_u32 s66, s66, 11010048
    s_lshl_b32 s48, s24, 2
    s_add_u32 s48, s48, s29
    s_mov_b32 s49, s27
    s_and_b32 s50, s29, 1
    s_lshl_b32 s50, s50, 1
    s_xor_b32 s50, s27, s50
    s_and_b32 s50, s50, 7
    s_and_b32 s54, s50, 3
    s_and_b32 s55, s50, 1
    s_lshl_b32 s53, s32, 2
    s_mul_i32 s58, s32, 14
    s_waitcnt lgkmcnt(0)
    s_mov_b32 s8, s4
    s_mov_b32 s9, s5
    s_lshl_b32 s64, s48, 3
    s_add_u32 s64, s64, s49
    s_lshl_b32 s64, s64, 2
    s_add_u32 s64, s64, s32
    s_lshl_b32 s64, s64, 7
    s_add_u32 s64, s64, 11010048
    s_xor_b32 s72, s50, 0
    s_and_b32 s36, s72, 4
    s_add_u32 s72, s72, s36
    s_add_u32 s72, s72, s58
    s_add_u32 s72, s72, 16
    s_lshl_b32 s72, s72, 10
    s_xor_b32 s73, s50, 1
    s_and_b32 s36, s73, 4
    s_add_u32 s73, s73, s36
    s_add_u32 s73, s73, s58
    s_add_u32 s73, s73, 16
    s_lshl_b32 s73, s73, 10
    s_xor_b32 s74, s50, 2
    s_and_b32 s36, s74, 4
    s_add_u32 s74, s74, s36
    s_add_u32 s74, s74, s58
    s_add_u32 s74, s74, 16
    s_lshl_b32 s74, s74, 10
    s_xor_b32 s75, s50, 3
    s_and_b32 s36, s75, 4
    s_add_u32 s75, s75, s36
    s_add_u32 s75, s75, s58
    s_add_u32 s75, s75, 16
    s_lshl_b32 s75, s75, 10
    s_xor_b32 s76, s50, 4
    s_and_b32 s36, s76, 4
    s_add_u32 s76, s76, s36
    s_add_u32 s76, s76, s58
    s_add_u32 s76, s76, 16
    s_lshl_b32 s76, s76, 10
    s_xor_b32 s77, s50, 5
    s_and_b32 s36, s77, 4
    s_add_u32 s77, s77, s36
    s_add_u32 s77, s77, s58
    s_add_u32 s77, s77, 16
    s_lshl_b32 s77, s77, 10
    s_xor_b32 s78, s50, 6
    s_and_b32 s36, s78, 4
    s_add_u32 s78, s78, s36
    s_add_u32 s78, s78, s58
    s_add_u32 s78, s78, 16
    s_lshl_b32 s78, s78, 10
    s_xor_b32 s79, s50, 7
    s_and_b32 s36, s79, 4
    s_add_u32 s79, s79, s36
    s_add_u32 s79, s79, s58
    s_add_u32 s79, s79, 16
    s_lshl_b32 s79, s79, 10
    s_xor_b32 s96, s54, 0
    s_add_u32 s96, s96, s53
    s_lshl_b32 s96, s96, 10
    s_xor_b32 s97, s54, 1
    s_add_u32 s97, s97, s53
    s_lshl_b32 s97, s97, 10
    s_xor_b32 s98, s54, 2
    s_add_u32 s98, s98, s53
    s_lshl_b32 s98, s98, 10
    s_xor_b32 s99, s54, 3
    s_add_u32 s99, s99, s53
    s_lshl_b32 s99, s99, 10
    s_xor_b32 s12, s54, 0
    s_and_b32 s36, s12, 2
    s_mul_i32 s36, s36, 3
    s_add_u32 s12, s12, s36
    s_add_u32 s12, s12, s58
    s_add_u32 s12, s12, 20
    s_lshl_b32 s12, s12, 10
    s_xor_b32 s13, s54, 1
    s_and_b32 s36, s13, 2
    s_mul_i32 s36, s36, 3
    s_add_u32 s13, s13, s36
    s_add_u32 s13, s13, s58
    s_add_u32 s13, s13, 20
    s_lshl_b32 s13, s13, 10
    s_xor_b32 s14, s54, 2
    s_and_b32 s36, s14, 2
    s_mul_i32 s36, s36, 3
    s_add_u32 s14, s14, s36
    s_add_u32 s14, s14, s58
    s_add_u32 s14, s14, 20
    s_lshl_b32 s14, s14, 10
    s_xor_b32 s15, s54, 3
    s_and_b32 s36, s15, 2
    s_mul_i32 s36, s36, 3
    s_add_u32 s15, s15, s36
    s_add_u32 s15, s15, s58
    s_add_u32 s15, s15, 20
    s_lshl_b32 s15, s15, 10
    s_xor_b32 s20, s55, 0
    s_add_u32 s20, s20, s58
    s_add_u32 s20, s20, 22
    s_lshl_b32 s20, s20, 10
    s_xor_b32 s21, s55, 1
    s_add_u32 s21, s21, s58
    s_add_u32 s21, s21, 22
    s_lshl_b32 s21, s21, 10
    s_cmp_ge_u32 s28, 8
    s_cbranch_scc1 L_FFN
    s_lshl_b32 s36, s31, 13
    v_add_u32 v4, s36, v44
    v_xor_b32 v5, 64, v4
    v_add_u32 v32, 0x10000, v4
    v_add_u32 v33, 0x10000, v5
    v_and_b32 v36, 7, v2
    v_lshrrev_b32 v37, 1, v36
    v_xor_b32 v37, v3, v37
    v_lshlrev_b32 v37, 4, v37
    v_lshl_or_b32 v37, v36, 7, v37
    s_mul_i32 s36, s31, 1088
    s_add_u32 s36, s36, 16384
    v_xor_b32 v6, s36, v37
    v_xor_b32 v7, 64, v6
    v_mul_u32_u24 v37, 3072, v3
    v_add_u32 v46, v46, v37
    v_xor_b32 v36, s32, v45
    v_lshl_add_u32 v8, v36, 5, v46
    s_lshl_b32 s67, s32, 6
    v_lshlrev_b32 v38, 4, v3
    v_lshl_add_u32 v38, v2, 8, v38
    s_lshl_b32 s36, s28, 4
    s_add_u32 s36, s36, s26
    s_lshl_b32 s36, s36, 10
    s_add_u32 s41, s36, s67
    s_add_u32 s41, s41, 10616832
    s_mov_b32 s44, 458759
    s_mov_b32 s45, 458759
    v_mov_b32 v24, s40
    v_mov_b32 v25, s40
    v_mov_b32 v26, s40
    v_mov_b32 v27, s40
    s_lshl_b32 s43, s26, 1
    s_add_u32 s43, s43, s31
    s_mul_i32 s43, s43, 294912
    v_and_b32 v10, 1, v3
    v_lshrrev_b32 v11, 1, v3
    v_lshlrev_b32 v39, 4, v2
    v_lshl_add_u32 v39, v11, 8, v39
    v_mul_u32_u24 v10, 73728, v10
    v_add_u32 v10, v10, v39
    s_lshl_b32 s51, s28, 1
    s_lshr_b32 s52, s32, 1
    s_add_u32 s51, s51, s52
    s_lshl_b32 s51, s51, 10
    s_add_u32 s51, s51, s43
    s_lshl_b32 s52, s35, 9
    s_add_u32 s51, s51, s52
    v_lshlrev_b32 v36, 2, v3
    v_sub_u32 v36, v2, v36
    s_mov_b32 s52, 0xf149f2ca
    v_mov_b32 v37, s52
    v_subrev_u32 v39, 0, v36
    v_cmp_gt_u32 vcc, 8, v39
    s_nop 1
    v_cndmask_b32_e64 v160, v37, 0, vcc
    v_cmp_gt_i32 vcc, -8, v39
    s_nop 1
    v_cndmask_b32_e64 v164, v37, 0, vcc
    v_cmp_le_i32 vcc, 0, v39
    s_nop 1
    v_cndmask_b32_e64 v50, 0, -1, vcc
    v_subrev_u32 v39, 1, v36
    v_cmp_gt_u32 vcc, 8, v39
    s_nop 1
    v_cndmask_b32_e64 v161, v37, 0, vcc
    v_cmp_gt_i32 vcc, -8, v39
    s_nop 1
    v_cndmask_b32_e64 v165, v37, 0, vcc
    v_cmp_le_i32 vcc, 0, v39
    s_nop 1
    v_cndmask_b32_e64 v51, 0, -1, vcc
    v_subrev_u32 v39, 2, v36
    v_cmp_gt_u32 vcc, 8, v39
    s_nop 1
    v_cndmask_b32_e64 v162, v37, 0, vcc
    v_cmp_gt_i32 vcc, -8, v39
    s_nop 1
    v_cndmask_b32_e64 v166, v37, 0, vcc
    v_cmp_le_i32 vcc, 0, v39
    s_nop 1
    v_cndmask_b32_e64 v52, 0, -1, vcc
    v_subrev_u32 v39, 3, v36
    v_cmp_gt_u32 vcc, 8, v39
    s_nop 1
    v_cndmask_b32_e64 v163, v37, 0, vcc
    v_cmp_gt_i32 vcc, -8, v39
    s_nop 1
    v_cndmask_b32_e64 v167, v37, 0, vcc
    v_cmp_le_i32 vcc, 0, v39
    s_nop 1
    v_cndmask_b32_e64 v53, 0, -1, vcc
    s_mov_b32 s36, 0xffff
    v_bfi_b32 v34, s36, v50, v51
    v_bfi_b32 v35, s36, v52, v53
    s_cmp_eq_u32 s26, 0
    s_cselect_b32 s52, s52, 0
    v_min_f32 v28, s52, v164
    v_min_f32 v29, s52, v165
    v_min_f32 v30, s52, v166
    v_min_f32 v31, s52, v167
    s_mov_b32 s30, s31
    v_add_u32 v9, 0x10000, v6
    v_add_u32 v11, 0x10000, v7
    v_add_u32 v39, 0x10000, v8
    v_mov_b32 v36, 163328
    s_waitcnt vmcnt(0)
    s_barrier
    ds_read_b64_tr_b16 v[60:61], v8 offset:61440
    ds_read_b64_tr_b16 v[62:63], v8 offset:61952
    ds_read_b128 v[40:43], v4 offset:43008
    ds_read_b128 v[44:47], v4 offset:45056
    ds_read_b128 v[48:51], v4 offset:47104
    ds_read_b128 v[52:55], v4 offset:49152
    ds_read_b64_tr_b16 v[64:65], v8 offset:62464
    ds_read_b64_tr_b16 v[66:67], v8 offset:62976
    ds_read_b128 v[56:59], v6 offset:43008
    ds_read_b64_tr_b16 v[68:69], v8 offset:63488
    ds_read_b64_tr_b16 v[70:71], v8 offset:64000
    s_waitcnt lgkmcnt(0)
    s_cmp_lg_u32 s31, 0
    s_cbranch_scc1 QKV_NOCS1
    v_mfma_f32_16x16x32_bf16 v[12:15], v[60:63], v[24:27], 0
    v_mfma_f32_16x16x32_bf16 v[16:19], v[64:67], v[24:27], 0
    v_mfma_f32_16x16x32_bf16 v[20:23], v[68:71], v[24:27], 0
QKV_NOCS1:
    v_mfma_f32_16x16x32_bf16 v[104:107], v[60:63], v[40:43], 0
    ds_read_b64_tr_b16 v[92:93], v39 offset:8192
    v_mfma_f32_16x16x32_bf16 v[108:111], v[60:63], v[44:47], 0
    ds_read_b64_tr_b16 v[94:95], v39 offset:8704
    v_mfma_f32_16x16x32_bf16 v[112:115], v[60:63], v[48:51], 0
    ds_read_b128 v[72:75], v5 offset:43008
    s_cmp_lg_u32 s31, 0
    s_cbranch_scc1 QKV_NOCS2
    v_cmp_eq_u32 vcc, 1, v2
    s_nop 1
    v_cndmask_b32 v12, v12, v16, vcc
    v_cndmask_b32 v13, v13, v17, vcc
    v_cndmask_b32 v14, v14, v18, vcc
    v_cndmask_b32 v15, v15, v19, vcc
    v_cmp_eq_u32 vcc, 2, v2
    s_nop 1
    v_cndmask_b32 v12, v12, v20, vcc
    v_cndmask_b32 v13, v13, v21, vcc
    v_cndmask_b32 v14, v14, v22, vcc
    v_cndmask_b32 v15, v15, v23, vcc
    s_mov_b64 exec, s[44:45]
    buffer_store_dwordx4 v[12:15], v38, s[16:19], s41 offen sc1
    s_mov_b64 exec, -1
QKV_NOCS2:
    v_mfma_f32_16x16x32_bf16 v[116:119], v[60:63], v[52:55], 0
    ds_read_b128 v[76:79], v5 offset:45056
    v_mfma_f32_16x16x32_bf16 v[124:127], v[64:67], v[40:43], 0
    ds_read_b128 v[80:83], v5 offset:47104
    v_mfma_f32_16x16x32_bf16 v[128:131], v[64:67], v[44:47], 0
    ds_read_b128 v[84:87], v5 offset:49152
    v_mfma_f32_16x16x32_bf16 v[132:135], v[64:67], v[48:51], 0
    ds_read_b64_tr_b16 v[96:97], v39 offset:9216
    v_mfma_f32_16x16x32_bf16 v[136:139], v[64:67], v[52:55], 0
    ds_read_b64_tr_b16 v[98:99], v39 offset:9728
    v_mfma_f32_16x16x32_bf16 v[120:123], v[64:67], v[56:59], 0
    ds_read_b128 v[88:91], v7 offset:43008
    v_mfma_f32_16x16x32_bf16 v[140:143], v[56:59], v[68:71], 0
    ds_read_b64_tr_b16 v[100:101], v39 offset:10240
    v_mfma_f32_16x16x32_bf16 v[144:147], v[40:43], v[68:71], 0
    ds_read_b64_tr_b16 v[102:103], v39 offset:10752
    v_mfma_f32_16x16x32_bf16 v[148:151], v[44:47], v[68:71], 0
    v_mfma_f32_16x16x32_bf16 v[152:155], v[48:51], v[68:71], 0
    v_mfma_f32_16x16x32_bf16 v[156:159], v[52:55], v[68:71], 0
    s_waitcnt lgkmcnt(8)
    v_mfma_f32_16x16x32_bf16 v[104:107], v[92:95], v[72:75], v[104:107]
    s_waitcnt lgkmcnt(7)
    v_mfma_f32_16x16x32_bf16 v[108:111], v[92:95], v[76:79], v[108:111]
    s_waitcnt lgkmcnt(6)
    v_mfma_f32_16x16x32_bf16 v[112:115], v[92:95], v[80:83], v[112:115]
    s_waitcnt vmcnt(0) lgkmcnt(0)
    s_barrier
    ds_read_b64_tr_b16 v[60:61], v39 offset:38912
    ds_read_b64_tr_b16 v[62:63], v39 offset:39424
    v_mfma_f32_16x16x32_bf16 v[116:119], v[92:95], v[84:87], v[116:119]
    ds_read_b128 v[40:43], v32 offset:20480
    v_mfma_f32_16x16x32_bf16 v[124:127], v[96:99], v[72:75], v[124:127]
    ds_read_b128 v[44:47], v32 offset:22528
    v_mfma_f32_16x16x32_bf16 v[128:131], v[96:99], v[76:79], v[128:131]
    ds_read_b128 v[48:51], v32 offset:24576
    v_mfma_f32_16x16x32_bf16 v[132:135], v[96:99], v[80:83], v[132:135]
    ds_read_b128 v[52:55], v32 offset:26624
    v_mfma_f32_16x16x32_bf16 v[136:139], v[96:99], v[84:87], v[136:139]
    ds_read_b64_tr_b16 v[64:65], v39 offset:39936
    v_mfma_f32_16x16x32_bf16 v[120:123], v[96:99], v[88:91], v[120:123]
    ds_read_b64_tr_b16 v[66:67], v39 offset:40448
    v_mfma_f32_16x16x32_bf16 v[140:143], v[88:91], v[100:103], v[140:143]
    ds_read_b128 v[56:59], v9 offset:20480
    v_mfma_f32_16x16x32_bf16 v[144:147], v[72:75], v[100:103], v[144:147]
    ds_read_b64_tr_b16 v[68:69], v39 offset:40960
    v_mfma_f32_16x16x32_bf16 v[148:151], v[76:79], v[100:103], v[148:151]
    ds_read_b64_tr_b16 v[70:71], v39 offset:41472
    v_mfma_f32_16x16x32_bf16 v[152:155], v[80:83], v[100:103], v[152:155]
    v_mfma_f32_16x16x32_bf16 v[156:159], v[84:87], v[100:103], v[156:159]
    s_waitcnt lgkmcnt(8)
    v_mfma_f32_16x16x32_bf16 v[104:107], v[60:63], v[40:43], v[104:107]
    ds_read_b64_tr_b16 v[92:93], v39 offset:51200
    s_waitcnt lgkmcnt(8)
    v_mfma_f32_16x16x32_bf16 v[108:111], v[60:63], v[44:47], v[108:111]
    ds_read_b64_tr_b16 v[94:95], v39 offset:51712
    s_waitcnt lgkmcnt(8)
    v_mfma_f32_16x16x32_bf16 v[112:115], v[60:63], v[48:51], v[112:115]
    ds_read_b128 v[72:75], v33 offset:20480
    s_waitcnt lgkmcnt(8)
    v_mfma_f32_16x16x32_bf16 v[116:119], v[60:63], v[52:55], v[116:119]
    ds_read_b128 v[76:79], v33 offset:22528
    s_waitcnt lgkmcnt(7)
    v_mfma_f32_16x16x32_bf16 v[124:127], v[64:67], v[40:43], v[124:127]
    ds_read_b128 v[80:83], v33 offset:24576
    v_mfma_f32_16x16x32_bf16 v[128:131], v[64:67], v[44:47], v[128:131]
    ds_read_b128 v[84:87], v33 offset:26624
    v_mfma_f32_16x16x32_bf16 v[132:135], v[64:67], v[48:51], v[132:135]
    ds_read_b64_tr_b16 v[96:97], v39 offset:52224
    v_mfma_f32_16x16x32_bf16 v[136:139], v[64:67], v[52:55], v[136:139]
    ds_read_b64_tr_b16 v[98:99], v39 offset:52736
    s_waitcnt lgkmcnt(10)
    v_mfma_f32_16x16x32_bf16 v[120:123], v[64:67], v[56:59], v[120:123]
    ds_read_b128 v[88:91], v11 offset:20480
    s_waitcnt lgkmcnt(9)
    v_mfma_f32_16x16x32_bf16 v[140:143], v[56:59], v[68:71], v[140:143]
    ds_read_b64_tr_b16 v[100:101], v39 offset:53248
    v_mfma_f32_16x16x32_bf16 v[144:147], v[40:43], v[68:71], v[144:147]
    ds_read_b64_tr_b16 v[102:103], v39 offset:53760
    v_mfma_f32_16x16x32_bf16 v[148:151], v[44:47], v[68:71], v[148:151]
    v_mfma_f32_16x16x32_bf16 v[152:155], v[48:51], v[68:71], v[152:155]
    v_mfma_f32_16x16x32_bf16 v[156:159], v[52:55], v[68:71], v[156:159]
    s_waitcnt lgkmcnt(8)
    v_mfma_f32_16x16x32_bf16 v[104:107], v[92:95], v[72:75], v[104:107]
    s_waitcnt lgkmcnt(7)
    v_mfma_f32_16x16x32_bf16 v[108:111], v[92:95], v[76:79], v[108:111]
    s_waitcnt lgkmcnt(6)
    v_mfma_f32_16x16x32_bf16 v[112:115], v[92:95], v[80:83], v[112:115]
    s_waitcnt lgkmcnt(0)
    s_barrier
    ds_read_b64_tr_b16 v[60:61], v8 offset:18432
    ds_read_b64_tr_b16 v[62:63], v8 offset:18944
    v_mfma_f32_16x16x32_bf16 v[116:119], v[92:95], v[84:87], v[116:119]
    ds_read_b128 v[40:43], v4 offset:0
    v_mfma_f32_16x16x32_bf16 v[124:127], v[96:99], v[72:75], v[124:127]
    ds_read_b128 v[44:47], v4 offset:2048
    v_mfma_f32_16x16x32_bf16 v[128:131], v[96:99], v[76:79], v[128:131]
    ds_read_b128 v[48:51], v4 offset:4096
    v_mfma_f32_16x16x32_bf16 v[132:135], v[96:99], v[80:83], v[132:135]
    ds_read_b128 v[52:55], v4 offset:6144
    v_mfma_f32_16x16x32_bf16 v[136:139], v[96:99], v[84:87], v[136:139]
    ds_read_b64_tr_b16 v[64:65], v8 offset:19456
    v_mfma_f32_16x16x32_bf16 v[120:123], v[96:99], v[88:91], v[120:123]
    ds_read_b64_tr_b16 v[66:67], v8 offset:19968
    v_mfma_f32_16x16x32_bf16 v[140:143], v[88:91], v[100:103], v[140:143]
    ds_read_b128 v[56:59], v6 offset:0
    v_mfma_f32_16x16x32_bf16 v[144:147], v[72:75], v[100:103], v[144:147]
    ds_read_b64_tr_b16 v[68:69], v8 offset:20480
    v_mfma_f32_16x16x32_bf16 v[148:151], v[76:79], v[100:103], v[148:151]
    ds_read_b64_tr_b16 v[70:71], v8 offset:20992
    v_mfma_f32_16x16x32_bf16 v[152:155], v[80:83], v[100:103], v[152:155]
    v_mfma_f32_16x16x32_bf16 v[156:159], v[84:87], v[100:103], v[156:159]
    s_waitcnt lgkmcnt(8)
    v_mfma_f32_16x16x32_bf16 v[104:107], v[60:63], v[40:43], v[104:107]
    ds_read_b64_tr_b16 v[92:93], v8 offset:30720
    s_waitcnt lgkmcnt(8)
    v_mfma_f32_16x16x32_bf16 v[108:111], v[60:63], v[44:47], v[108:111]
    ds_read_b64_tr_b16 v[94:95], v8 offset:31232
    s_waitcnt lgkmcnt(8)
    v_mfma_f32_16x16x32_bf16 v[112:115], v[60:63], v[48:51], v[112:115]
    ds_read_b128 v[72:75], v5 offset:0
    s_waitcnt lgkmcnt(8)
    v_mfma_f32_16x16x32_bf16 v[116:119], v[60:63], v[52:55], v[116:119]
    ds_read_b128 v[76:79], v5 offset:2048
    s_waitcnt lgkmcnt(7)
    v_mfma_f32_16x16x32_bf16 v[124:127], v[64:67], v[40:43], v[124:127]
    ds_read_b128 v[80:83], v5 offset:4096
    v_mfma_f32_16x16x32_bf16 v[128:131], v[64:67], v[44:47], v[128:131]
    ds_read_b128 v[84:87], v5 offset:6144
    v_mfma_f32_16x16x32_bf16 v[132:135], v[64:67], v[48:51], v[132:135]
    ds_read_b64_tr_b16 v[96:97], v8 offset:31744
    v_mfma_f32_16x16x32_bf16 v[136:139], v[64:67], v[52:55], v[136:139]
    ds_read_b64_tr_b16 v[98:99], v8 offset:32256
    s_waitcnt lgkmcnt(10)
    v_mfma_f32_16x16x32_bf16 v[120:123], v[64:67], v[56:59], v[120:123]
    ds_read_b128 v[88:91], v7 offset:0
    s_waitcnt lgkmcnt(9)
    v_mfma_f32_16x16x32_bf16 v[140:143], v[56:59], v[68:71], v[140:143]
    ds_read_b64_tr_b16 v[100:101], v8 offset:32768
    v_mfma_f32_16x16x32_bf16 v[144:147], v[40:43], v[68:71], v[144:147]
    ds_read_b64_tr_b16 v[102:103], v8 offset:33280
    v_mfma_f32_16x16x32_bf16 v[148:151], v[44:47], v[68:71], v[148:151]
    v_mfma_f32_16x16x32_bf16 v[152:155], v[48:51], v[68:71], v[152:155]
    v_mfma_f32_16x16x32_bf16 v[156:159], v[52:55], v[68:71], v[156:159]
    s_waitcnt lgkmcnt(8)
    v_mfma_f32_16x16x32_bf16 v[104:107], v[92:95], v[72:75], v[104:107]
    s_waitcnt lgkmcnt(7)
    v_mfma_f32_16x16x32_bf16 v[108:111], v[92:95], v[76:79], v[108:111]
    s_waitcnt lgkmcnt(6)
    v_mfma_f32_16x16x32_bf16 v[112:115], v[92:95], v[80:83], v[112:115]
    s_waitcnt lgkmcnt(0)
    s_barrier
    ds_read_b64_tr_b16 v[60:61], v8 offset:61440
    ds_read_b64_tr_b16 v[62:63], v8 offset:61952
    v_mfma_f32_16x16x32_bf16 v[116:119], v[92:95], v[84:87], v[116:119]
    ds_read_b128 v[40:43], v4 offset:43008
    v_mfma_f32_16x16x32_bf16 v[124:127], v[96:99], v[72:75], v[124:127]
    ds_read_b128 v[44:47], v4 offset:45056
    v_mfma_f32_16x16x32_bf16 v[128:131], v[96:99], v[76:79], v[128:131]
    ds_read_b128 v[48:51], v4 offset:47104
    v_mfma_f32_16x16x32_bf16 v[132:135], v[96:99], v[80:83], v[132:135]
    ds_read_b128 v[52:55], v4 offset:49152
    v_mfma_f32_16x16x32_bf16 v[136:139], v[96:99], v[84:87], v[136:139]
    ds_read_b64_tr_b16 v[64:65], v8 offset:62464
    v_mfma_f32_16x16x32_bf16 v[120:123], v[96:99], v[88:91], v[120:123]
    ds_read_b64_tr_b16 v[66:67], v8 offset:62976
    v_mfma_f32_16x16x32_bf16 v[140:143], v[88:91], v[100:103], v[140:143]
    ds_read_b128 v[56:59], v6 offset:43008
    v_mfma_f32_16x16x32_bf16 v[144:147], v[72:75], v[100:103], v[144:147]
    ds_read_b64_tr_b16 v[68:69], v8 offset:63488
    v_mfma_f32_16x16x32_bf16 v[148:151], v[76:79], v[100:103], v[148:151]
    ds_read_b64_tr_b16 v[70:71], v8 offset:64000
    v_mfma_f32_16x16x32_bf16 v[152:155], v[80:83], v[100:103], v[152:155]
    v_mfma_f32_16x16x32_bf16 v[156:159], v[84:87], v[100:103], v[156:159]
    s_waitcnt lgkmcnt(8)
    v_mfma_f32_16x16x32_bf16 v[104:107], v[60:63], v[40:43], v[104:107]
    ds_read_b64_tr_b16 v[92:93], v39 offset:8192
    s_waitcnt lgkmcnt(8)
    v_mfma_f32_16x16x32_bf16 v[108:111], v[60:63], v[44:47], v[108:111]
    ds_read_b64_tr_b16 v[94:95], v39 offset:8704
    s_waitcnt lgkmcnt(8)
    v_mfma_f32_16x16x32_bf16 v[112:115], v[60:63], v[48:51], v[112:115]
    ds_read_b128 v[72:75], v5 offset:43008
    s_waitcnt lgkmcnt(8)
    v_mfma_f32_16x16x32_bf16 v[116:119], v[60:63], v[52:55], v[116:119]
    ds_read_b128 v[76:79], v5 offset:45056
    s_waitcnt lgkmcnt(7)
    v_mfma_f32_16x16x32_bf16 v[124:127], v[64:67], v[40:43], v[124:127]
    ds_read_b128 v[80:83], v5 offset:47104
    v_mfma_f32_16x16x32_bf16 v[128:131], v[64:67], v[44:47], v[128:131]
    ds_read_b128 v[84:87], v5 offset:49152
    v_mfma_f32_16x16x32_bf16 v[132:135], v[64:67], v[48:51], v[132:135]
    ds_read_b64_tr_b16 v[96:97], v39 offset:9216
    v_mfma_f32_16x16x32_bf16 v[136:139], v[64:67], v[52:55], v[136:139]
    ds_read_b64_tr_b16 v[98:99], v39 offset:9728
    s_waitcnt lgkmcnt(10)
    v_mfma_f32_16x16x32_bf16 v[120:123], v[64:67], v[56:59], v[120:123]
    ds_read_b128 v[88:91], v7 offset:43008
    s_waitcnt lgkmcnt(9)
    v_mfma_f32_16x16x32_bf16 v[140:143], v[56:59], v[68:71], v[140:143]
    ds_read_b64_tr_b16 v[100:101], v39 offset:10240
    v_mfma_f32_16x16x32_bf16 v[144:147], v[40:43], v[68:71], v[144:147]
    ds_read_b64_tr_b16 v[102:103], v39 offset:10752
    v_mfma_f32_16x16x32_bf16 v[148:151], v[44:47], v[68:71], v[148:151]
    v_mfma_f32_16x16x32_bf16 v[152:155], v[48:51], v[68:71], v[152:155]
    v_mfma_f32_16x16x32_bf16 v[156:159], v[52:55], v[68:71], v[156:159]
    s_waitcnt lgkmcnt(8)
    v_mfma_f32_16x16x32_bf16 v[104:107], v[92:95], v[72:75], v[104:107]
    s_waitcnt lgkmcnt(7)
    v_mfma_f32_16x16x32_bf16 v[108:111], v[92:95], v[76:79], v[108:111]
    s_waitcnt lgkmcnt(6)
    v_mfma_f32_16x16x32_bf16 v[112:115], v[92:95], v[80:83], v[112:115]
    s_waitcnt lgkmcnt(0)
    s_barrier
    ds_read_b64_tr_b16 v[60:61], v39 offset:38912
    ds_read_b64_tr_b16 v[62:63], v39 offset:39424
    v_mfma_f32_16x16x32_bf16 v[116:119], v[92:95], v[84:87], v[116:119]
    ds_read_b128 v[40:43], v32 offset:20480
    v_mfma_f32_16x16x32_bf16 v[124:127], v[96:99], v[72:75], v[124:127]
    ds_read_b128 v[44:47], v32 offset:22528
    v_mfma_f32_16x16x32_bf16 v[128:131], v[96:99], v[76:79], v[128:131]
    ds_read_b128 v[48:51], v32 offset:24576
    v_mfma_f32_16x16x32_bf16 v[132:135], v[96:99], v[80:83], v[132:135]
    ds_read_b128 v[52:55], v32 offset:26624
    v_mfma_f32_16x16x32_bf16 v[136:139], v[96:99], v[84:87], v[136:139]
    ds_read_b64_tr_b16 v[64:65], v39 offset:39936
    v_mfma_f32_16x16x32_bf16 v[120:123], v[96:99], v[88:91], v[120:123]
    ds_read_b64_tr_b16 v[66:67], v39 offset:40448
    v_mfma_f32_16x16x32_bf16 v[140:143], v[88:91], v[100:103], v[140:143]
    ds_read_b128 v[56:59], v9 offset:20480
    v_mfma_f32_16x16x32_bf16 v[144:147], v[72:75], v[100:103], v[144:147]
    ds_read_b64_tr_b16 v[68:69], v39 offset:40960
    v_mfma_f32_16x16x32_bf16 v[148:151], v[76:79], v[100:103], v[148:151]
    ds_read_b64_tr_b16 v[70:71], v39 offset:41472
    v_mfma_f32_16x16x32_bf16 v[152:155], v[80:83], v[100:103], v[152:155]
    v_mfma_f32_16x16x32_bf16 v[156:159], v[84:87], v[100:103], v[156:159]
    s_waitcnt lgkmcnt(8)
    v_mfma_f32_16x16x32_bf16 v[104:107], v[60:63], v[40:43], v[104:107]
    ds_read_b64_tr_b16 v[92:93], v39 offset:51200
    s_waitcnt lgkmcnt(8)
    v_mfma_f32_16x16x32_bf16 v[108:111], v[60:63], v[44:47], v[108:111]
    ds_read_b64_tr_b16 v[94:95], v39 offset:51712
    s_waitcnt lgkmcnt(8)
    v_mfma_f32_16x16x32_bf16 v[112:115], v[60:63], v[48:51], v[112:115]
    ds_read_b128 v[72:75], v33 offset:20480
    s_waitcnt lgkmcnt(8)
    v_mfma_f32_16x16x32_bf16 v[116:119], v[60:63], v[52:55], v[116:119]
    ds_read_b128 v[76:79], v33 offset:22528
    s_waitcnt lgkmcnt(7)
    v_mfma_f32_16x16x32_bf16 v[124:127], v[64:67], v[40:43], v[124:127]
    ds_read_b128 v[80:83], v33 offset:24576
    v_mfma_f32_16x16x32_bf16 v[128:131], v[64:67], v[44:47], v[128:131]
    ds_read_b128 v[84:87], v33 offset:26624
    v_mfma_f32_16x16x32_bf16 v[132:135], v[64:67], v[48:51], v[132:135]
    ds_read_b64_tr_b16 v[96:97], v39 offset:52224
    v_mfma_f32_16x16x32_bf16 v[136:139], v[64:67], v[52:55], v[136:139]
    ds_read_b64_tr_b16 v[98:99], v39 offset:52736
    s_waitcnt lgkmcnt(10)
    v_mfma_f32_16x16x32_bf16 v[120:123], v[64:67], v[56:59], v[120:123]
    ds_read_b128 v[88:91], v11 offset:20480
    s_waitcnt lgkmcnt(9)
    v_mfma_f32_16x16x32_bf16 v[140:143], v[56:59], v[68:71], v[140:143]
    ds_read_b64_tr_b16 v[100:101], v39 offset:53248
    v_mfma_f32_16x16x32_bf16 v[144:147], v[40:43], v[68:71], v[144:147]
    ds_read_b64_tr_b16 v[102:103], v39 offset:53760
    v_mfma_f32_16x16x32_bf16 v[148:151], v[44:47], v[68:71], v[148:151]
    v_mfma_f32_16x16x32_bf16 v[152:155], v[48:51], v[68:71], v[152:155]
    v_mfma_f32_16x16x32_bf16 v[156:159], v[52:55], v[68:71], v[156:159]
    s_waitcnt lgkmcnt(8)
    v_mfma_f32_16x16x32_bf16 v[104:107], v[92:95], v[72:75], v[104:107]
    s_waitcnt lgkmcnt(7)
    v_mfma_f32_16x16x32_bf16 v[108:111], v[92:95], v[76:79], v[108:111]
    s_waitcnt lgkmcnt(6)
    v_mfma_f32_16x16x32_bf16 v[112:115], v[92:95], v[80:83], v[112:115]
    s_waitcnt lgkmcnt(0)
    s_barrier
    ds_read_b64_tr_b16 v[60:61], v8 offset:18432
    ds_read_b64_tr_b16 v[62:63], v8 offset:18944
    v_mfma_f32_16x16x32_bf16 v[116:119], v[92:95], v[84:87], v[116:119]
    ds_read_b128 v[40:43], v4 offset:0
    v_mfma_f32_16x16x32_bf16 v[124:127], v[96:99], v[72:75], v[124:127]
    ds_read_b128 v[44:47], v4 offset:2048
    v_mfma_f32_16x16x32_bf16 v[128:131], v[96:99], v[76:79], v[128:131]
    ds_read_b128 v[48:51], v4 offset:4096
    v_mfma_f32_16x16x32_bf16 v[132:135], v[96:99], v[80:83], v[132:135]
    ds_read_b128 v[52:55], v4 offset:6144
    v_mfma_f32_16x16x32_bf16 v[136:139], v[96:99], v[84:87], v[136:139]
    ds_read_b64_tr_b16 v[64:65], v8 offset:19456
    v_mfma_f32_16x16x32_bf16 v[120:123], v[96:99], v[88:91], v[120:123]
    ds_read_b64_tr_b16 v[66:67], v8 offset:19968
    v_mfma_f32_16x16x32_bf16 v[140:143], v[88:91], v[100:103], v[140:143]
    ds_read_b128 v[56:59], v6 offset:0
    v_mfma_f32_16x16x32_bf16 v[144:147], v[72:75], v[100:103], v[144:147]
    ds_read_b64_tr_b16 v[68:69], v8 offset:20480
    v_mfma_f32_16x16x32_bf16 v[148:151], v[76:79], v[100:103], v[148:151]
    ds_read_b64_tr_b16 v[70:71], v8 offset:20992
    v_mfma_f32_16x16x32_bf16 v[152:155], v[80:83], v[100:103], v[152:155]
    v_mfma_f32_16x16x32_bf16 v[156:159], v[84:87], v[100:103], v[156:159]
    s_waitcnt lgkmcnt(8)
    v_mfma_f32_16x16x32_bf16 v[104:107], v[60:63], v[40:43], v[104:107]
    ds_read_b64_tr_b16 v[92:93], v8 offset:30720
    s_waitcnt lgkmcnt(8)
    v_mfma_f32_16x16x32_bf16 v[108:111], v[60:63], v[44:47], v[108:111]
    ds_read_b64_tr_b16 v[94:95], v8 offset:31232
    s_waitcnt lgkmcnt(8)
    v_mfma_f32_16x16x32_bf16 v[112:115], v[60:63], v[48:51], v[112:115]
    ds_read_b128 v[72:75], v5 offset:0
    s_waitcnt lgkmcnt(8)
    v_mfma_f32_16x16x32_bf16 v[116:119], v[60:63], v[52:55], v[116:119]
    ds_read_b128 v[76:79], v5 offset:2048
    s_waitcnt lgkmcnt(7)
    v_mfma_f32_16x16x32_bf16 v[124:127], v[64:67], v[40:43], v[124:127]
    ds_read_b128 v[80:83], v5 offset:4096
    v_mfma_f32_16x16x32_bf16 v[128:131], v[64:67], v[44:47], v[128:131]
    ds_read_b128 v[84:87], v5 offset:6144
    v_mfma_f32_16x16x32_bf16 v[132:135], v[64:67], v[48:51], v[132:135]
    ds_read_b64_tr_b16 v[96:97], v8 offset:31744
    v_mfma_f32_16x16x32_bf16 v[136:139], v[64:67], v[52:55], v[136:139]
    ds_read_b64_tr_b16 v[98:99], v8 offset:32256
    s_waitcnt lgkmcnt(10)
    v_mfma_f32_16x16x32_bf16 v[120:123], v[64:67], v[56:59], v[120:123]
    ds_read_b128 v[88:91], v7 offset:0
    s_waitcnt lgkmcnt(9)
    v_mfma_f32_16x16x32_bf16 v[140:143], v[56:59], v[68:71], v[140:143]
    ds_read_b64_tr_b16 v[100:101], v8 offset:32768
    v_mfma_f32_16x16x32_bf16 v[144:147], v[40:43], v[68:71], v[144:147]
    ds_read_b64_tr_b16 v[102:103], v8 offset:33280
    v_mfma_f32_16x16x32_bf16 v[148:151], v[44:47], v[68:71], v[148:151]
    v_mfma_f32_16x16x32_bf16 v[152:155], v[48:51], v[68:71], v[152:155]
    v_mfma_f32_16x16x32_bf16 v[156:159], v[52:55], v[68:71], v[156:159]
    s_waitcnt lgkmcnt(8)
    v_mfma_f32_16x16x32_bf16 v[104:107], v[92:95], v[72:75], v[104:107]
    s_waitcnt lgkmcnt(7)
    v_mfma_f32_16x16x32_bf16 v[108:111], v[92:95], v[76:79], v[108:111]
    s_waitcnt lgkmcnt(6)
    v_mfma_f32_16x16x32_bf16 v[112:115], v[92:95], v[80:83], v[112:115]
    s_waitcnt lgkmcnt(0)
    s_barrier
    ds_read_b64_tr_b16 v[60:61], v8 offset:61440
    ds_read_b64_tr_b16 v[62:63], v8 offset:61952
    v_mfma_f32_16x16x32_bf16 v[116:119], v[92:95], v[84:87], v[116:119]
    ds_read_b128 v[40:43], v4 offset:43008
    v_mfma_f32_16x16x32_bf16 v[124:127], v[96:99], v[72:75], v[124:127]
    ds_read_b128 v[44:47], v4 offset:45056
    v_mfma_f32_16x16x32_bf16 v[128:131], v[96:99], v[76:79], v[128:131]
    ds_read_b128 v[48:51], v4 offset:47104
    v_mfma_f32_16x16x32_bf16 v[132:135], v[96:99], v[80:83], v[132:135]
    ds_read_b128 v[52:55], v4 offset:49152
    v_mfma_f32_16x16x32_bf16 v[136:139], v[96:99], v[84:87], v[136:139]
    ds_read_b64_tr_b16 v[64:65], v8 offset:62464
    v_mfma_f32_16x16x32_bf16 v[120:123], v[96:99], v[88:91], v[120:123]
    ds_read_b64_tr_b16 v[66:67], v8 offset:62976
    v_mfma_f32_16x16x32_bf16 v[140:143], v[88:91], v[100:103], v[140:143]
    ds_read_b128 v[56:59], v6 offset:43008
    v_mfma_f32_16x16x32_bf16 v[144:147], v[72:75], v[100:103], v[144:147]
    ds_read_b64_tr_b16 v[68:69], v8 offset:63488
    v_mfma_f32_16x16x32_bf16 v[148:151], v[76:79], v[100:103], v[148:151]
    ds_read_b64_tr_b16 v[70:71], v8 offset:64000
    v_mfma_f32_16x16x32_bf16 v[152:155], v[80:83], v[100:103], v[152:155]
    v_mfma_f32_16x16x32_bf16 v[156:159], v[84:87], v[100:103], v[156:159]
    s_waitcnt lgkmcnt(8)
    v_mfma_f32_16x16x32_bf16 v[104:107], v[60:63], v[40:43], v[104:107]
    ds_read_b64_tr_b16 v[92:93], v39 offset:8192
    s_waitcnt lgkmcnt(8)
    v_mfma_f32_16x16x32_bf16 v[108:111], v[60:63], v[44:47], v[108:111]
    ds_read_b64_tr_b16 v[94:95], v39 offset:8704
    s_waitcnt lgkmcnt(8)
    v_mfma_f32_16x16x32_bf16 v[112:115], v[60:63], v[48:51], v[112:115]
    ds_read_b128 v[72:75], v5 offset:43008
    s_waitcnt lgkmcnt(8)
    v_mfma_f32_16x16x32_bf16 v[116:119], v[60:63], v[52:55], v[116:119]
    ds_read_b128 v[76:79], v5 offset:45056
    s_waitcnt lgkmcnt(7)
    v_mfma_f32_16x16x32_bf16 v[124:127], v[64:67], v[40:43], v[124:127]
    ds_read_b128 v[80:83], v5 offset:47104
    v_mfma_f32_16x16x32_bf16 v[128:131], v[64:67], v[44:47], v[128:131]
    ds_read_b128 v[84:87], v5 offset:49152
    v_mfma_f32_16x16x32_bf16 v[132:135], v[64:67], v[48:51], v[132:135]
    ds_read_b32 v37, v36 offset:192
    v_mfma_f32_16x16x32_bf16 v[136:139], v[64:67], v[52:55], v[136:139]
    ds_read_b64_tr_b16 v[96:97], v39 offset:9216
    s_waitcnt lgkmcnt(10)
    v_mfma_f32_16x16x32_bf16 v[120:123], v[64:67], v[56:59], v[120:123]
    ds_read_b64_tr_b16 v[98:99], v39 offset:9728
    s_waitcnt lgkmcnt(9)
    v_mfma_f32_16x16x32_bf16 v[140:143], v[56:59], v[68:71], v[140:143]
    ds_read_b128 v[88:91], v7 offset:43008
    v_mfma_f32_16x16x32_bf16 v[144:147], v[40:43], v[68:71], v[144:147]
    ds_read_b64_tr_b16 v[100:101], v39 offset:10240
    v_mfma_f32_16x16x32_bf16 v[148:151], v[44:47], v[68:71], v[148:151]
    ds_read_b64_tr_b16 v[102:103], v39 offset:10752
    v_mfma_f32_16x16x32_bf16 v[152:155], v[48:51], v[68:71], v[152:155]
    v_mov_b32 v38, 1
    s_mov_b64 exec, 1
    ds_add_u32 v36, v38 offset:120
    s_mov_b64 exec, -1
    v_mfma_f32_16x16x32_bf16 v[156:159], v[52:55], v[68:71], v[156:159]
    s_waitcnt lgkmcnt(6)
    v_readfirstlane_b32 s36, v37
    s_nop 0
    s_cmp_lt_u32 s36, 4
    s_cbranch_scc1 QKV_LF7
QKV_LF7_OK:
    v_mfma_f32_16x16x32_bf16 v[104:107], v[92:95], v[72:75], v[104:107]
    ds_read_b64_tr_b16 v[60:61], v39 offset:38912
    v_mfma_f32_16x16x32_bf16 v[108:111], v[92:95], v[76:79], v[108:111]
    ds_read_b64_tr_b16 v[62:63], v39 offset:39424
    v_mfma_f32_16x16x32_bf16 v[112:115], v[92:95], v[80:83], v[112:115]
    ds_read_b128 v[40:43], v32 offset:20480
    v_mfma_f32_16x16x32_bf16 v[116:119], v[92:95], v[84:87], v[116:119]
    ds_read_b128 v[44:47], v32 offset:22528
    s_waitcnt lgkmcnt(8)
    v_mfma_f32_16x16x32_bf16 v[124:127], v[96:99], v[72:75], v[124:127]
    ds_read_b128 v[48:51], v32 offset:24576
    v_mfma_f32_16x16x32_bf16 v[128:131], v[96:99], v[76:79], v[128:131]
    ds_read_b128 v[52:55], v32 offset:26624
    v_mfma_f32_16x16x32_bf16 v[132:135], v[96:99], v[80:83], v[132:135]
    v_mfma_f32_16x16x32_bf16 v[136:139], v[96:99], v[84:87], v[136:139]
    ds_read_b64_tr_b16 v[64:65], v39 offset:39936
    s_waitcnt lgkmcnt(10)
    v_mfma_f32_16x16x32_bf16 v[120:123], v[96:99], v[88:91], v[120:123]
    ds_read_b64_tr_b16 v[66:67], v39 offset:40448
    s_waitcnt lgkmcnt(9)
    v_mfma_f32_16x16x32_bf16 v[140:143], v[88:91], v[100:103], v[140:143]
    ds_read_b128 v[56:59], v9 offset:20480
    v_mfma_f32_16x16x32_bf16 v[144:147], v[72:75], v[100:103], v[144:147]
    ds_read_b64_tr_b16 v[68:69], v39 offset:40960
    v_mfma_f32_16x16x32_bf16 v[148:151], v[76:79], v[100:103], v[148:151]
    ds_read_b64_tr_b16 v[70:71], v39 offset:41472
    v_mfma_f32_16x16x32_bf16 v[152:155], v[80:83], v[100:103], v[152:155]
    v_mfma_f32_16x16x32_bf16 v[156:159], v[84:87], v[100:103], v[156:159]
    s_waitcnt lgkmcnt(8)
    v_mfma_f32_16x16x32_bf16 v[104:107], v[60:63], v[40:43], v[104:107]
    ds_read_b64_tr_b16 v[92:93], v39 offset:51200
    s_waitcnt lgkmcnt(8)
    v_mfma_f32_16x16x32_bf16 v[108:111], v[60:63], v[44:47], v[108:111]
    ds_read_b64_tr_b16 v[94:95], v39 offset:51712
    s_waitcnt lgkmcnt(8)
    v_mfma_f32_16x16x32_bf16 v[112:115], v[60:63], v[48:51], v[112:115]
    ds_read_b128 v[72:75], v33 offset:20480
    s_waitcnt lgkmcnt(8)
    v_mfma_f32_16x16x32_bf16 v[116:119], v[60:63], v[52:55], v[116:119]
    ds_read_b128 v[76:79], v33 offset:22528
    s_waitcnt lgkmcnt(7)
    v_mfma_f32_16x16x32_bf16 v[124:127], v[64:67], v[40:43], v[124:127]
    ds_read_b128 v[80:83], v33 offset:24576
    v_mfma_f32_16x16x32_bf16 v[128:131], v[64:67], v[44:47], v[128:131]
    ds_read_b128 v[84:87], v33 offset:26624
    v_mfma_f32_16x16x32_bf16 v[132:135], v[64:67], v[48:51], v[132:135]
    ds_read_b64_tr_b16 v[96:97], v39 offset:52224
    v_mfma_f32_16x16x32_bf16 v[136:139], v[64:67], v[52:55], v[136:139]
    ds_read_b64_tr_b16 v[98:99], v39 offset:52736
    s_waitcnt lgkmcnt(10)
    v_mfma_f32_16x16x32_bf16 v[120:123], v[64:67], v[56:59], v[120:123]
    ds_read_b128 v[88:91], v11 offset:20480
    s_waitcnt lgkmcnt(9)
    v_mfma_f32_16x16x32_bf16 v[140:143], v[56:59], v[68:71], v[140:143]
    ds_read_b64_tr_b16 v[100:101], v39 offset:53248
    v_mfma_f32_16x16x32_bf16 v[144:147], v[40:43], v[68:71], v[144:147]
    ds_read_b64_tr_b16 v[102:103], v39 offset:53760
    v_mfma_f32_16x16x32_bf16 v[148:151], v[44:47], v[68:71], v[148:151]
    v_mov_b32 v38, 1
    s_mov_b64 exec, 1
    ds_add_u32 v36, v38 offset:124
    s_mov_b64 exec, -1
    v_mfma_f32_16x16x32_bf16 v[152:155], v[48:51], v[68:71], v[152:155]
    v_mfma_f32_16x16x32_bf16 v[156:159], v[52:55], v[68:71], v[156:159]
    s_waitcnt lgkmcnt(9)
    v_mfma_f32_16x16x32_bf16 v[104:107], v[92:95], v[72:75], v[104:107]
    s_waitcnt lgkmcnt(8)
    v_mfma_f32_16x16x32_bf16 v[108:111], v[92:95], v[76:79], v[108:111]
    s_waitcnt lgkmcnt(7)
    v_mfma_f32_16x16x32_bf16 v[112:115], v[92:95], v[80:83], v[112:115]
    s_waitcnt lgkmcnt(6)
    v_mfma_f32_16x16x32_bf16 v[116:119], v[92:95], v[84:87], v[116:119]
    s_waitcnt lgkmcnt(4)
    v_mfma_f32_16x16x32_bf16 v[124:127], v[96:99], v[72:75], v[124:127]
    v_mfma_f32_16x16x32_bf16 v[128:131], v[96:99], v[76:79], v[128:131]
    v_mfma_f32_16x16x32_bf16 v[132:135], v[96:99], v[80:83], v[132:135]
    v_mfma_f32_16x16x32_bf16 v[136:139], v[96:99], v[84:87], v[136:139]
    s_waitcnt lgkmcnt(3)
    v_mfma_f32_16x16x32_bf16 v[120:123], v[96:99], v[88:91], v[120:123]
    s_waitcnt lgkmcnt(1)
    v_mfma_f32_16x16x32_bf16 v[140:143], v[88:91], v[100:103], v[140:143]
    v_mfma_f32_16x16x32_bf16 v[144:147], v[72:75], v[100:103], v[144:147]
    v_mfma_f32_16x16x32_bf16 v[148:151], v[76:79], v[100:103], v[148:151]
    ds_read_b32 v37, v36 offset:8
    v_mfma_f32_16x16x32_bf16 v[152:155], v[80:83], v[100:103], v[152:155]
    v_mfma_f32_16x16x32_bf16 v[156:159], v[84:87], v[100:103], v[156:159]
    s_waitcnt lgkmcnt(0)
    v_readfirstlane_b32 s36, v37
    s_nop 0
    s_cmp_lt_u32 s36, 4
    s_cbranch_scc1 QKV_SSP
QKV_SSP_OK:
    s_mov_b32 s60, 3216550459
    s_mov_b32 s61, 3216550459
    s_lshl_b32 s36, s31, 10
    s_add_u32 s36, s36, 159744
    v_lshl_add_u32 v36, v2, 4, s36
    s_add_u32 s42, s67, 162048
    v_lshl_add_u32 v37, v3, 4, s42
    ds_read_b128 v[72:75], v36
    ds_read_b128 v[12:15], v37 offset:0
    ds_read_b128 v[16:19], v37 offset:256
    ds_read_b128 v[76:79], v36 offset:256
    ds_read_b128 v[80:83], v36 offset:512
    ds_read_b128 v[84:87], v36 offset:768
    v_and_b32 v4, 7, v2
    s_lshl_b32 s36, s31, 7
    s_add_u32 s36, s36, 161792
    v_lshl_add_u32 v4, v4, 4, s36
    ds_read_b128 v[88:91], v4
    v_lshl_add_u32 v5, v2, 2, s42
    ds_read_b32 v32, v5 offset:512
    ds_read_b32 v33, v5 offset:512
    s_lshl_b32 s36, s31, 8
    s_add_u32 s36, s36, 147456
    v_lshl_add_u32 v6, v3, 4, s36
    s_lshl_b32 s36, s31, 5
    s_add_u32 s36, s36, 147968
    v_and_b32 v7, 16, v0
    v_add_u32 v7, s36, v7
    s_waitcnt lgkmcnt(3)
    ds_read_b128 v[40:43], v6 offset:0
    ds_read_b128 v[44:47], v6 offset:576
    ds_read_b128 v[48:51], v6 offset:64
    ds_read_b128 v[52:55], v6 offset:640
    ds_read_b128 v[56:59], v6 offset:128
    ds_read_b128 v[60:63], v6 offset:704
    ds_read_b128 v[64:67], v6 offset:192
    ds_read_b128 v[68:71], v6 offset:768
    ds_read_b128 v[36:39], v7
    ds_read_b128 v[20:23], v7 offset:576
    v_pk_fma_f32 v[104:105], v[12:13], v[72:73], v[104:105]
    v_pk_fma_f32 v[106:107], v[14:15], v[72:73], v[106:107]
    v_pk_mul_f32 v[104:105], v[104:105], v[74:75]
    v_pk_mul_f32 v[106:107], v[106:107], v[74:75]
    v_cvt_pk_bf16_f32 v92, v104, v105
    v_cvt_pk_bf16_f32 v93, v106, v107
    v_pk_fma_f32 v[108:109], v[12:13], v[76:77], v[108:109]
    v_pk_fma_f32 v[110:111], v[14:15], v[76:77], v[110:111]
    v_pk_mul_f32 v[108:109], v[108:109], v[78:79]
    v_pk_mul_f32 v[110:111], v[110:111], v[78:79]
    v_cvt_pk_bf16_f32 v94, v108, v109
    v_cvt_pk_bf16_f32 v95, v110, v111
    v_pk_fma_f32 v[112:113], v[12:13], v[80:81], v[112:113]
    v_pk_fma_f32 v[114:115], v[14:15], v[80:81], v[114:115]
    v_pk_mul_f32 v[112:113], v[112:113], v[82:83]
    v_pk_mul_f32 v[114:115], v[114:115], v[82:83]
    v_cvt_pk_bf16_f32 v96, v112, v113
    v_cvt_pk_bf16_f32 v97, v114, v115
    v_pk_fma_f32 v[116:117], v[12:13], v[84:85], v[116:117]
    v_pk_fma_f32 v[118:119], v[14:15], v[84:85], v[118:119]
    v_pk_mul_f32 v[116:117], v[116:117], v[86:87]
    v_pk_mul_f32 v[118:119], v[118:119], v[86:87]
    v_cvt_pk_bf16_f32 v98, v116, v117
    v_cvt_pk_bf16_f32 v99, v118, v119
    s_waitcnt lgkmcnt(10)
    v_pk_fma_f32 v[120:121], v[16:17], v[88:89], v[120:121]
    v_pk_fma_f32 v[122:123], v[18:19], v[88:89], v[122:123]
    v_pk_mul_f32 v[120:121], v[120:121], v[90:91]
    v_pk_mul_f32 v[122:123], v[122:123], v[90:91]
    v_cvt_pk_bf16_f32 v4, v120, v121
    v_cvt_pk_bf16_f32 v5, v122, v123
    v_pk_fma_f32 v[124:125], v[16:17], v[72:73], v[124:125]
    v_pk_fma_f32 v[126:127], v[18:19], v[72:73], v[126:127]
    v_pk_mul_f32 v[124:125], v[124:125], v[74:75]
    v_pk_mul_f32 v[126:127], v[126:127], v[74:75]
    v_cvt_pk_bf16_f32 v6, v124, v125
    v_cvt_pk_bf16_f32 v7, v126, v127
    v_pk_fma_f32 v[128:129], v[16:17], v[76:77], v[128:129]
    v_pk_fma_f32 v[130:131], v[18:19], v[76:77], v[130:131]
    v_pk_mul_f32 v[128:129], v[128:129], v[78:79]
    v_pk_mul_f32 v[130:131], v[130:131], v[78:79]
    v_cvt_pk_bf16_f32 v8, v128, v129
    v_cvt_pk_bf16_f32 v9, v130, v131
    v_pk_fma_f32 v[132:133], v[16:17], v[80:81], v[132:133]
    v_pk_fma_f32 v[134:135], v[18:19], v[80:81], v[134:135]
    v_pk_mul_f32 v[132:133], v[132:133], v[82:83]
    v_pk_mul_f32 v[134:135], v[134:135], v[82:83]
    v_cvt_pk_bf16_f32 v100, v132, v133
    v_cvt_pk_bf16_f32 v101, v134, v135
    v_pk_fma_f32 v[136:137], v[16:17], v[84:85], v[136:137]
    v_pk_fma_f32 v[138:139], v[18:19], v[84:85], v[138:139]
    v_pk_mul_f32 v[136:137], v[136:137], v[86:87]
    v_pk_mul_f32 v[138:139], v[138:139], v[86:87]
    v_cvt_pk_bf16_f32 v102, v136, v137
    v_cvt_pk_bf16_f32 v103, v138, v139
    v_mfma_f32_16x16x16_bf16 v[104:107], v[6:7], v[92:93], v[160:163]
    v_mfma_f32_16x16x16_bf16 v[108:111], v[4:5], v[92:93], v[28:31]
    v_mfma_f32_16x16x16_bf16 v[112:115], v[8:9], v[94:95], v[160:163]
    v_mfma_f32_16x16x16_bf16 v[116:119], v[6:7], v[94:95], v[164:167]
    v_mfma_f32_16x16x16_bf16 v[120:123], v[100:101], v[96:97], v[160:163]
    v_mfma_f32_16x16x16_bf16 v[124:127], v[8:9], v[96:97], v[164:167]
    v_mfma_f32_16x16x16_bf16 v[128:131], v[102:103], v[98:99], v[160:163]
    v_mfma_f32_16x16x16_bf16 v[132:135], v[100:101], v[98:99], v[164:167]
    s_waitcnt lgkmcnt(0)
    v_pk_fma_f32 v[140:141], v[36:37], v[32:33], v[140:141]
    v_pk_fma_f32 v[142:143], v[38:39], v[32:33], v[142:143]
    v_pk_mul_f32 v[140:141], v[140:141], v[20:21]
    v_pk_mul_f32 v[142:143], v[142:143], v[22:23]
    v_cvt_pk_bf16_f32 v72, v140, v141
    v_cvt_pk_bf16_f32 v73, v142, v143
    v_pk_fma_f32 v[144:145], v[40:41], v[32:33], v[144:145]
    v_pk_fma_f32 v[146:147], v[42:43], v[32:33], v[146:147]
    v_pk_mul_f32 v[144:145], v[144:145], v[44:45]
    v_pk_mul_f32 v[146:147], v[146:147], v[46:47]
    v_cvt_pk_bf16_f32 v74, v144, v145
    v_cvt_pk_bf16_f32 v75, v146, v147
    v_pk_fma_f32 v[148:149], v[48:49], v[32:33], v[148:149]
    v_pk_fma_f32 v[150:151], v[50:51], v[32:33], v[150:151]
    v_pk_mul_f32 v[148:149], v[148:149], v[52:53]
    v_pk_mul_f32 v[150:151], v[150:151], v[54:55]
    v_cvt_pk_bf16_f32 v76, v148, v149
    v_cvt_pk_bf16_f32 v77, v150, v151
    v_pk_fma_f32 v[152:153], v[56:57], v[32:33], v[152:153]
    v_pk_fma_f32 v[154:155], v[58:59], v[32:33], v[154:155]
    v_pk_mul_f32 v[152:153], v[152:153], v[60:61]
    v_pk_mul_f32 v[154:155], v[154:155], v[62:63]
    v_cvt_pk_bf16_f32 v78, v152, v153
    v_cvt_pk_bf16_f32 v79, v154, v155
    v_pk_fma_f32 v[156:157], v[64:65], v[32:33], v[156:157]
    v_pk_fma_f32 v[158:159], v[66:67], v[32:33], v[158:159]
    v_pk_mul_f32 v[156:157], v[156:157], v[68:69]
    v_pk_mul_f32 v[158:159], v[158:159], v[70:71]
    v_cvt_pk_bf16_f32 v80, v156, v157
    v_cvt_pk_bf16_f32 v81, v158, v159
    s_mov_b32 s60, 0x3eb8aa3b
    v_max_f32 v104, v104, v108
    v_max_f32 v105, v105, v109
    v_max_f32 v106, v106, v110
    v_max_f32 v107, v107, v111
    v_max_f32 v112, v112, v116
    v_max_f32 v113, v113, v117
    v_max_f32 v114, v114, v118
    v_max_f32 v115, v115, v119
    v_max_f32 v120, v120, v124
    v_max_f32 v121, v121, v125
    v_max_f32 v122, v122, v126
    v_max_f32 v123, v123, v127
    v_max_f32 v128, v128, v132
    v_max_f32 v129, v129, v133
    v_max_f32 v130, v130, v134
    v_max_f32 v131, v131, v135
    v_max3_f32 v12, v104, v105, v106
    v_max3_f32 v13, v112, v113, v114
    v_max3_f32 v14, v120, v121, v122
    v_max3_f32 v15, v128, v129, v130
    v_max_f32 v12, v12, v107
    v_max_f32 v13, v13, v115
    v_max_f32 v14, v14, v123
    v_max_f32 v15, v15, v131
    v_permlane32_swap_b32 v12, v13
    s_nop 0
    v_permlane32_swap_b32 v14, v15
    v_max_f32 v12, v12, v13
    v_max_f32 v14, v14, v15
    s_nop 1
    v_permlane16_swap_b32 v12, v14
    v_max_f32 v12, v12, v14
    v_mul_f32 v12, s60, v12
    v_mov_b32 v14, v12
    s_nop 1
    v_permlane16_swap_b32 v12, v14
    v_mov_b32 v13, v12
    v_mov_b32 v15, v14
    s_nop 0
    v_permlane32_swap_b32 v12, v13
    v_permlane32_swap_b32 v14, v15
    v_fma_f32 v104, v104, s60, -v12
    v_fma_f32 v105, v105, s60, -v12
    v_fma_f32 v106, v106, s60, -v12
    v_fma_f32 v107, v107, s60, -v12
    v_exp_f32 v104, v104
    v_exp_f32 v105, v105
    v_exp_f32 v106, v106
    v_exp_f32 v107, v107
    v_fma_f32 v112, v112, s60, -v13
    v_fma_f32 v113, v113, s60, -v13
    v_fma_f32 v114, v114, s60, -v13
    v_fma_f32 v115, v115, s60, -v13
    v_exp_f32 v112, v112
    v_exp_f32 v113, v113
    v_exp_f32 v114, v114
    v_exp_f32 v115, v115
    v_fma_f32 v120, v120, s60, -v14
    v_fma_f32 v121, v121, s60, -v14
    v_fma_f32 v122, v122, s60, -v14
    v_fma_f32 v123, v123, s60, -v14
    v_exp_f32 v120, v120
    v_exp_f32 v121, v121
    v_exp_f32 v122, v122
    v_exp_f32 v123, v123
    v_fma_f32 v128, v128, s60, -v15
    v_fma_f32 v129, v129, s60, -v15
    v_fma_f32 v130, v130, s60, -v15
    v_fma_f32 v131, v131, s60, -v15
    v_exp_f32 v128, v128
    v_exp_f32 v129, v129
    v_exp_f32 v130, v130
    v_exp_f32 v131, v131
    v_cvt_pk_bf16_f32 v104, v104, v105
    v_cvt_pk_bf16_f32 v105, v106, v107
    v_bfi_b32 v108, v34, 0, v104
    v_bfi_b32 v109, v35, 0, v105
    v_and_b32 v110, v34, v104
    v_and_b32 v111, v35, v105
    v_cvt_pk_bf16_f32 v112, v112, v113
    v_cvt_pk_bf16_f32 v113, v114, v115
    v_bfi_b32 v116, v34, 0, v112
    v_bfi_b32 v117, v35, 0, v113
    v_and_b32 v118, v34, v112
    v_and_b32 v119, v35, v113
    v_cvt_pk_bf16_f32 v120, v120, v121
    v_cvt_pk_bf16_f32 v121, v122, v123
    v_bfi_b32 v124, v34, 0, v120
    v_bfi_b32 v125, v35, 0, v121
    v_and_b32 v126, v34, v120
    v_and_b32 v127, v35, v121
    v_cvt_pk_bf16_f32 v128, v128, v129
    v_cvt_pk_bf16_f32 v129, v130, v131
    v_bfi_b32 v132, v34, 0, v128
    v_bfi_b32 v133, v35, 0, v129
    v_and_b32 v134, v34, v128
    v_and_b32 v135, v35, v129
    v_mfma_f32_16x16x32_bf16 v[140:143], v[24:27], v[108:111], 0
    v_mfma_f32_16x16x32_bf16 v[136:139], v[72:75], v[108:111], 0
    v_mfma_f32_16x16x32_bf16 v[148:151], v[24:27], v[116:119], 0
    v_mfma_f32_16x16x32_bf16 v[144:147], v[74:77], v[116:119], 0
    v_mfma_f32_16x16x32_bf16 v[156:159], v[24:27], v[124:127], 0
    v_mfma_f32_16x16x32_bf16 v[152:155], v[76:79], v[124:127], 0
    v_mfma_f32_16x16x32_bf16 v[164:167], v[24:27], v[132:135], 0
    v_mfma_f32_16x16x32_bf16 v[160:163], v[78:81], v[132:135], 0
    s_nop 0
    v_rcp_f32 v140, v140
    s_nop 0
    v_rcp_f32 v148, v148
    s_nop 0
    v_rcp_f32 v156, v156
    s_nop 0
    v_rcp_f32 v164, v164
    v_mul_f32 v136, v136, v140
    v_mul_f32 v137, v137, v140
    v_mul_f32 v138, v138, v140
    v_mul_f32 v139, v139, v140
    v_cvt_pk_bf16_f32 v104, v136, v137
    v_cvt_pk_bf16_f32 v105, v138, v139
    v_mul_f32 v144, v144, v148
    v_mul_f32 v145, v145, v148
    v_mul_f32 v146, v146, v148
    v_mul_f32 v147, v147, v148
    v_cvt_pk_bf16_f32 v106, v144, v145
    v_cvt_pk_bf16_f32 v107, v146, v147
    s_nop 0
    v_permlane16_swap_b32 v104, v106
    v_permlane16_swap_b32 v105, v107
    buffer_store_dwordx4 v[104:107], v10, s[16:19], s51 offen sc1
    s_add_u32 s51, s51, 147456
    v_mul_f32 v152, v152, v156
    v_mul_f32 v153, v153, v156
    v_mul_f32 v154, v154, v156
    v_mul_f32 v155, v155, v156
    v_cvt_pk_bf16_f32 v108, v152, v153
    v_cvt_pk_bf16_f32 v109, v154, v155
    v_mul_f32 v160, v160, v164
    v_mul_f32 v161, v161, v164
    v_mul_f32 v162, v162, v164
    v_mul_f32 v163, v163, v164
    v_cvt_pk_bf16_f32 v110, v160, v161
    v_cvt_pk_bf16_f32 v111, v162, v163
    s_nop 0
    v_permlane16_swap_b32 v108, v110
    v_permlane16_swap_b32 v109, v111
    buffer_store_dwordx4 v[108:111], v10, s[16:19], s51 offen sc1
    s_add_u32 s51, s51, 147456
    s_branch L_P2
L_FFN:
    s_sub_u32 s37, s28, 8
    s_and_b32 s39, s37, 1
    s_cmp_ge_u32 s3, 4
    s_cbranch_scc1 L_FFN3
    s_lshl_b32 s36, s35, 13
    v_add_u32 v4, s36, v44
    v_xor_b32 v5, 64, v4
    v_add_u32 v32, 0x10000, v4
    v_add_u32 v33, 0x10000, v5
    s_lshr_b32 s36, s3, 1
    s_lshl_b32 s67, s36, 8
    s_lshl_b32 s36, s36, 10
    v_mul_u32_u24 v37, 3072, v3
    v_add3_u32 v46, v46, v37, s36
    v_xor_b32 v36, 0, v45
    v_lshl_add_u32 v6, v36, 5, v46
    v_add_u32 v10, 0x10000, v6
    v_xor_b32 v36, 1, v45
    v_lshl_add_u32 v7, v36, 5, v46
    v_add_u32 v11, 0x10000, v7
    v_xor_b32 v36, 2, v45
    v_lshl_add_u32 v8, v36, 5, v46
    v_add_u32 v34, 0x10000, v8
    v_xor_b32 v36, 3, v45
    v_lshl_add_u32 v9, v36, 5, v46
    v_add_u32 v35, 0x10000, v9
    v_lshlrev_b32 v38, 4, v3
    v_lshl_add_u32 v38, v2, 6, v38
    s_lshl_b32 s36, s28, 4
    s_add_u32 s36, s36, s26
    s_lshl_b32 s36, s36, 10
    s_add_u32 s41, s36, s67
    s_add_u32 s41, s41, 10616832
    s_mov_b32 s44, 983055
    s_mov_b32 s45, 983055
    v_mov_b32 v28, s40
    v_mov_b32 v29, s40
    v_mov_b32 v30, s40
    v_mov_b32 v31, s40
    s_lshl_b32 s43, s26, 1
    s_add_u32 s43, s43, s35
    s_mul_i32 s43, s43, 294912
    s_mul_i32 s51, s37, 7
    s_add_u32 s51, s51, 16
    s_cmp_eq_u32 s39, 0
    s_cselect_b32 s52, 6, 0
    s_add_u32 s52, s52, s51
    s_add_u32 s51, s51, s39
    s_and_b32 s36, s3, 2
    s_add_u32 s51, s51, s36
    s_lshl_b32 s51, s51, 10
    s_add_u32 s51, s51, s43
    s_mov_b32 s30, s35
    v_mov_b32 v36, 163328
    s_waitcnt vmcnt(0)
    s_barrier
    ds_read_b64_tr_b16 v[56:57], v6 offset:61440
    ds_read_b64_tr_b16 v[58:59], v6 offset:61952
    ds_read_b128 v[40:43], v4 offset:43008
    ds_read_b128 v[44:47], v4 offset:45056
    ds_read_b128 v[48:51], v4 offset:47104
    ds_read_b128 v[52:55], v4 offset:49152
    ds_read_b64_tr_b16 v[60:61], v7 offset:61440
    ds_read_b64_tr_b16 v[62:63], v7 offset:61952
    ds_read_b64_tr_b16 v[64:65], v8 offset:61440
    ds_read_b64_tr_b16 v[66:67], v8 offset:61952
    ds_read_b64_tr_b16 v[68:69], v9 offset:61440
    ds_read_b64_tr_b16 v[70:71], v9 offset:61952
    s_waitcnt lgkmcnt(0)
    s_cmp_lg_u32 s35, 0
    s_cbranch_scc1 FFN4_NOCS1
    v_mfma_f32_16x16x32_bf16 v[12:15], v[56:59], v[28:31], 0
    v_mfma_f32_16x16x32_bf16 v[16:19], v[60:63], v[28:31], 0
    v_mfma_f32_16x16x32_bf16 v[20:23], v[64:67], v[28:31], 0
    v_mfma_f32_16x16x32_bf16 v[24:27], v[68:71], v[28:31], 0
FFN4_NOCS1:
    v_mfma_f32_16x16x32_bf16 v[104:107], v[56:59], v[40:43], 0
    ds_read_b64_tr_b16 v[88:89], v10 offset:8192
    v_mfma_f32_16x16x32_bf16 v[120:123], v[56:59], v[44:47], 0
    ds_read_b64_tr_b16 v[90:91], v10 offset:8704
    v_mfma_f32_16x16x32_bf16 v[136:139], v[56:59], v[48:51], 0
    ds_read_b128 v[72:75], v5 offset:43008
    s_cmp_lg_u32 s35, 0
    s_cbranch_scc1 FFN4_NOCS2
    v_cmp_eq_u32 vcc, 1, v2
    s_nop 1
    v_cndmask_b32 v12, v12, v16, vcc
    v_cndmask_b32 v13, v13, v17, vcc
    v_cndmask_b32 v14, v14, v18, vcc
    v_cndmask_b32 v15, v15, v19, vcc
    v_cmp_eq_u32 vcc, 2, v2
    s_nop 1
    v_cndmask_b32 v12, v12, v20, vcc
    v_cndmask_b32 v13, v13, v21, vcc
    v_cndmask_b32 v14, v14, v22, vcc
    v_cndmask_b32 v15, v15, v23, vcc
    v_cmp_eq_u32 vcc, 3, v2
    s_nop 1
    v_cndmask_b32 v12, v12, v24, vcc
    v_cndmask_b32 v13, v13, v25, vcc
    v_cndmask_b32 v14, v14, v26, vcc
    v_cndmask_b32 v15, v15, v27, vcc
    s_mov_b64 exec, s[44:45]
    buffer_store_dwordx4 v[12:15], v38, s[16:19], s41 offen sc1
    s_mov_b64 exec, -1
FFN4_NOCS2:
    v_mfma_f32_16x16x32_bf16 v[152:155], v[56:59], v[52:55], 0
    ds_read_b128 v[76:79], v5 offset:45056
    v_mfma_f32_16x16x32_bf16 v[108:111], v[60:63], v[40:43], 0
    ds_read_b128 v[80:83], v5 offset:47104
    v_mfma_f32_16x16x32_bf16 v[124:127], v[60:63], v[44:47], 0
    ds_read_b128 v[84:87], v5 offset:49152
    v_mfma_f32_16x16x32_bf16 v[140:143], v[60:63], v[48:51], 0
    v_mfma_f32_16x16x32_bf16 v[156:159], v[60:63], v[52:55], 0
    ds_read_b64_tr_b16 v[92:93], v11 offset:8192
    v_mfma_f32_16x16x32_bf16 v[112:115], v[64:67], v[40:43], 0
    ds_read_b64_tr_b16 v[94:95], v11 offset:8704
    v_mfma_f32_16x16x32_bf16 v[128:131], v[64:67], v[44:47], 0
    ds_read_b64_tr_b16 v[96:97], v34 offset:8192
    v_mfma_f32_16x16x32_bf16 v[144:147], v[64:67], v[48:51], 0
    ds_read_b64_tr_b16 v[98:99], v34 offset:8704
    v_mfma_f32_16x16x32_bf16 v[160:163], v[64:67], v[52:55], 0
    ds_read_b64_tr_b16 v[100:101], v35 offset:8192
    v_mfma_f32_16x16x32_bf16 v[116:119], v[68:71], v[40:43], 0
    ds_read_b64_tr_b16 v[102:103], v35 offset:8704
    v_mfma_f32_16x16x32_bf16 v[132:135], v[68:71], v[44:47], 0
    v_mfma_f32_16x16x32_bf16 v[148:151], v[68:71], v[48:51], 0
    v_mfma_f32_16x16x32_bf16 v[164:167], v[68:71], v[52:55], 0
    s_waitcnt lgkmcnt(9)
    v_mfma_f32_16x16x32_bf16 v[104:107], v[88:91], v[72:75], v[104:107]
    s_waitcnt lgkmcnt(8)
    v_mfma_f32_16x16x32_bf16 v[120:123], v[88:91], v[76:79], v[120:123]
    s_waitcnt lgkmcnt(7)
    v_mfma_f32_16x16x32_bf16 v[136:139], v[88:91], v[80:83], v[136:139]
    s_waitcnt vmcnt(0) lgkmcnt(0)
    s_barrier
    ds_read_b64_tr_b16 v[56:57], v10 offset:38912
    ds_read_b64_tr_b16 v[58:59], v10 offset:39424
    v_mfma_f32_16x16x32_bf16 v[152:155], v[88:91], v[84:87], v[152:155]
    ds_read_b128 v[40:43], v32 offset:20480
    v_mfma_f32_16x16x32_bf16 v[108:111], v[92:95], v[72:75], v[108:111]
    ds_read_b128 v[44:47], v32 offset:22528
    v_mfma_f32_16x16x32_bf16 v[124:127], v[92:95], v[76:79], v[124:127]
    ds_read_b128 v[48:51], v32 offset:24576
    v_mfma_f32_16x16x32_bf16 v[140:143], v[92:95], v[80:83], v[140:143]
    ds_read_b128 v[52:55], v32 offset:26624
    v_mfma_f32_16x16x32_bf16 v[156:159], v[92:95], v[84:87], v[156:159]
    ds_read_b64_tr_b16 v[60:61], v11 offset:38912
    v_mfma_f32_16x16x32_bf16 v[112:115], v[96:99], v[72:75], v[112:115]
    v_mfma_f32_16x16x32_bf16 v[128:131], v[96:99], v[76:79], v[128:131]
    ds_read_b64_tr_b16 v[62:63], v11 offset:39424
    v_mfma_f32_16x16x32_bf16 v[144:147], v[96:99], v[80:83], v[144:147]
    ds_read_b64_tr_b16 v[64:65], v34 offset:38912
    v_mfma_f32_16x16x32_bf16 v[160:163], v[96:99], v[84:87], v[160:163]
    ds_read_b64_tr_b16 v[66:67], v34 offset:39424
    v_mfma_f32_16x16x32_bf16 v[116:119], v[100:103], v[72:75], v[116:119]
    ds_read_b64_tr_b16 v[68:69], v35 offset:38912
    v_mfma_f32_16x16x32_bf16 v[132:135], v[100:103], v[76:79], v[132:135]
    ds_read_b64_tr_b16 v[70:71], v35 offset:39424
    v_mfma_f32_16x16x32_bf16 v[148:151], v[100:103], v[80:83], v[148:151]
    v_mfma_f32_16x16x32_bf16 v[164:167], v[100:103], v[84:87], v[164:167]
    s_waitcnt lgkmcnt(9)
    v_mfma_f32_16x16x32_bf16 v[104:107], v[56:59], v[40:43], v[104:107]
    ds_read_b64_tr_b16 v[88:89], v10 offset:51200
    s_waitcnt lgkmcnt(9)
    v_mfma_f32_16x16x32_bf16 v[120:123], v[56:59], v[44:47], v[120:123]
    ds_read_b64_tr_b16 v[90:91], v10 offset:51712
    s_waitcnt lgkmcnt(9)
    v_mfma_f32_16x16x32_bf16 v[136:139], v[56:59], v[48:51], v[136:139]
    ds_read_b128 v[72:75], v33 offset:20480
    s_waitcnt lgkmcnt(9)
    v_mfma_f32_16x16x32_bf16 v[152:155], v[56:59], v[52:55], v[152:155]
    ds_read_b128 v[76:79], v33 offset:22528
    s_waitcnt lgkmcnt(8)
    v_mfma_f32_16x16x32_bf16 v[108:111], v[60:63], v[40:43], v[108:111]
    ds_read_b128 v[80:83], v33 offset:24576
    v_mfma_f32_16x16x32_bf16 v[124:127], v[60:63], v[44:47], v[124:127]
    ds_read_b128 v[84:87], v33 offset:26624
    v_mfma_f32_16x16x32_bf16 v[140:143], v[60:63], v[48:51], v[140:143]
    v_mfma_f32_16x16x32_bf16 v[156:159], v[60:63], v[52:55], v[156:159]
    ds_read_b64_tr_b16 v[92:93], v11 offset:51200
    s_waitcnt lgkmcnt(9)
    v_mfma_f32_16x16x32_bf16 v[112:115], v[64:67], v[40:43], v[112:115]
    ds_read_b64_tr_b16 v[94:95], v11 offset:51712
    v_mfma_f32_16x16x32_bf16 v[128:131], v[64:67], v[44:47], v[128:131]
    ds_read_b64_tr_b16 v[96:97], v34 offset:51200
    v_mfma_f32_16x16x32_bf16 v[144:147], v[64:67], v[48:51], v[144:147]
    ds_read_b64_tr_b16 v[98:99], v34 offset:51712
    v_mfma_f32_16x16x32_bf16 v[160:163], v[64:67], v[52:55], v[160:163]
    ds_read_b64_tr_b16 v[100:101], v35 offset:51200
    s_waitcnt lgkmcnt(11)
    v_mfma_f32_16x16x32_bf16 v[116:119], v[68:71], v[40:43], v[116:119]
    ds_read_b64_tr_b16 v[102:103], v35 offset:51712
    v_mfma_f32_16x16x32_bf16 v[132:135], v[68:71], v[44:47], v[132:135]
    v_mfma_f32_16x16x32_bf16 v[148:151], v[68:71], v[48:51], v[148:151]
    v_mfma_f32_16x16x32_bf16 v[164:167], v[68:71], v[52:55], v[164:167]
    s_waitcnt lgkmcnt(9)
    v_mfma_f32_16x16x32_bf16 v[104:107], v[88:91], v[72:75], v[104:107]
    s_waitcnt lgkmcnt(8)
    v_mfma_f32_16x16x32_bf16 v[120:123], v[88:91], v[76:79], v[120:123]
    s_waitcnt lgkmcnt(7)
    v_mfma_f32_16x16x32_bf16 v[136:139], v[88:91], v[80:83], v[136:139]
    s_waitcnt lgkmcnt(0)
    s_barrier
    ds_read_b64_tr_b16 v[56:57], v6 offset:18432
    ds_read_b64_tr_b16 v[58:59], v6 offset:18944
    v_mfma_f32_16x16x32_bf16 v[152:155], v[88:91], v[84:87], v[152:155]
    ds_read_b128 v[40:43], v4 offset:0
    v_mfma_f32_16x16x32_bf16 v[108:111], v[92:95], v[72:75], v[108:111]
    ds_read_b128 v[44:47], v4 offset:2048
    v_mfma_f32_16x16x32_bf16 v[124:127], v[92:95], v[76:79], v[124:127]
    ds_read_b128 v[48:51], v4 offset:4096
    v_mfma_f32_16x16x32_bf16 v[140:143], v[92:95], v[80:83], v[140:143]
    ds_read_b128 v[52:55], v4 offset:6144
    v_mfma_f32_16x16x32_bf16 v[156:159], v[92:95], v[84:87], v[156:159]
    ds_read_b64_tr_b16 v[60:61], v7 offset:18432
    v_mfma_f32_16x16x32_bf16 v[112:115], v[96:99], v[72:75], v[112:115]
    v_mfma_f32_16x16x32_bf16 v[128:131], v[96:99], v[76:79], v[128:131]
    ds_read_b64_tr_b16 v[62:63], v7 offset:18944
    v_mfma_f32_16x16x32_bf16 v[144:147], v[96:99], v[80:83], v[144:147]
    ds_read_b64_tr_b16 v[64:65], v8 offset:18432
    v_mfma_f32_16x16x32_bf16 v[160:163], v[96:99], v[84:87], v[160:163]
    ds_read_b64_tr_b16 v[66:67], v8 offset:18944
    v_mfma_f32_16x16x32_bf16 v[116:119], v[100:103], v[72:75], v[116:119]
    ds_read_b64_tr_b16 v[68:69], v9 offset:18432
    v_mfma_f32_16x16x32_bf16 v[132:135], v[100:103], v[76:79], v[132:135]
    ds_read_b64_tr_b16 v[70:71], v9 offset:18944
    v_mfma_f32_16x16x32_bf16 v[148:151], v[100:103], v[80:83], v[148:151]
    v_mfma_f32_16x16x32_bf16 v[164:167], v[100:103], v[84:87], v[164:167]
    s_waitcnt lgkmcnt(9)
    v_mfma_f32_16x16x32_bf16 v[104:107], v[56:59], v[40:43], v[104:107]
    ds_read_b64_tr_b16 v[88:89], v6 offset:30720
    s_waitcnt lgkmcnt(9)
    v_mfma_f32_16x16x32_bf16 v[120:123], v[56:59], v[44:47], v[120:123]
    ds_read_b64_tr_b16 v[90:91], v6 offset:31232
    s_waitcnt lgkmcnt(9)
    v_mfma_f32_16x16x32_bf16 v[136:139], v[56:59], v[48:51], v[136:139]
    ds_read_b128 v[72:75], v5 offset:0
    s_waitcnt lgkmcnt(9)
    v_mfma_f32_16x16x32_bf16 v[152:155], v[56:59], v[52:55], v[152:155]
    ds_read_b128 v[76:79], v5 offset:2048
    s_waitcnt lgkmcnt(8)
    v_mfma_f32_16x16x32_bf16 v[108:111], v[60:63], v[40:43], v[108:111]
    ds_read_b128 v[80:83], v5 offset:4096
    v_mfma_f32_16x16x32_bf16 v[124:127], v[60:63], v[44:47], v[124:127]
    ds_read_b128 v[84:87], v5 offset:6144
    v_mfma_f32_16x16x32_bf16 v[140:143], v[60:63], v[48:51], v[140:143]
    v_mfma_f32_16x16x32_bf16 v[156:159], v[60:63], v[52:55], v[156:159]
    ds_read_b64_tr_b16 v[92:93], v7 offset:30720
    s_waitcnt lgkmcnt(9)
    v_mfma_f32_16x16x32_bf16 v[112:115], v[64:67], v[40:43], v[112:115]
    ds_read_b64_tr_b16 v[94:95], v7 offset:31232
    v_mfma_f32_16x16x32_bf16 v[128:131], v[64:67], v[44:47], v[128:131]
    ds_read_b64_tr_b16 v[96:97], v8 offset:30720
    v_mfma_f32_16x16x32_bf16 v[144:147], v[64:67], v[48:51], v[144:147]
    ds_read_b64_tr_b16 v[98:99], v8 offset:31232
    v_mfma_f32_16x16x32_bf16 v[160:163], v[64:67], v[52:55], v[160:163]
    ds_read_b64_tr_b16 v[100:101], v9 offset:30720
    s_waitcnt lgkmcnt(11)
    v_mfma_f32_16x16x32_bf16 v[116:119], v[68:71], v[40:43], v[116:119]
    ds_read_b64_tr_b16 v[102:103], v9 offset:31232
    v_mfma_f32_16x16x32_bf16 v[132:135], v[68:71], v[44:47], v[132:135]
    v_mfma_f32_16x16x32_bf16 v[148:151], v[68:71], v[48:51], v[148:151]
    v_mfma_f32_16x16x32_bf16 v[164:167], v[68:71], v[52:55], v[164:167]
    s_waitcnt lgkmcnt(9)
    v_mfma_f32_16x16x32_bf16 v[104:107], v[88:91], v[72:75], v[104:107]
    s_waitcnt lgkmcnt(8)
    v_mfma_f32_16x16x32_bf16 v[120:123], v[88:91], v[76:79], v[120:123]
    s_waitcnt lgkmcnt(7)
    v_mfma_f32_16x16x32_bf16 v[136:139], v[88:91], v[80:83], v[136:139]
    s_waitcnt lgkmcnt(0)
    s_barrier
    ds_read_b64_tr_b16 v[56:57], v6 offset:61440
    ds_read_b64_tr_b16 v[58:59], v6 offset:61952
    v_mfma_f32_16x16x32_bf16 v[152:155], v[88:91], v[84:87], v[152:155]
    ds_read_b128 v[40:43], v4 offset:43008
    v_mfma_f32_16x16x32_bf16 v[108:111], v[92:95], v[72:75], v[108:111]
    ds_read_b128 v[44:47], v4 offset:45056
    v_mfma_f32_16x16x32_bf16 v[124:127], v[92:95], v[76:79], v[124:127]
    ds_read_b128 v[48:51], v4 offset:47104
    v_mfma_f32_16x16x32_bf16 v[140:143], v[92:95], v[80:83], v[140:143]
    ds_read_b128 v[52:55], v4 offset:49152
    v_mfma_f32_16x16x32_bf16 v[156:159], v[92:95], v[84:87], v[156:159]
    ds_read_b64_tr_b16 v[60:61], v7 offset:61440
    v_mfma_f32_16x16x32_bf16 v[112:115], v[96:99], v[72:75], v[112:115]
    v_mfma_f32_16x16x32_bf16 v[128:131], v[96:99], v[76:79], v[128:131]
    ds_read_b64_tr_b16 v[62:63], v7 offset:61952
    v_mfma_f32_16x16x32_bf16 v[144:147], v[96:99], v[80:83], v[144:147]
    ds_read_b64_tr_b16 v[64:65], v8 offset:61440
    v_mfma_f32_16x16x32_bf16 v[160:163], v[96:99], v[84:87], v[160:163]
    ds_read_b64_tr_b16 v[66:67], v8 offset:61952
    v_mfma_f32_16x16x32_bf16 v[116:119], v[100:103], v[72:75], v[116:119]
    ds_read_b64_tr_b16 v[68:69], v9 offset:61440
    v_mfma_f32_16x16x32_bf16 v[132:135], v[100:103], v[76:79], v[132:135]
    ds_read_b64_tr_b16 v[70:71], v9 offset:61952
    v_mfma_f32_16x16x32_bf16 v[148:151], v[100:103], v[80:83], v[148:151]
    v_mfma_f32_16x16x32_bf16 v[164:167], v[100:103], v[84:87], v[164:167]
    s_waitcnt lgkmcnt(9)
    v_mfma_f32_16x16x32_bf16 v[104:107], v[56:59], v[40:43], v[104:107]
    ds_read_b64_tr_b16 v[88:89], v10 offset:8192
    s_waitcnt lgkmcnt(9)
    v_mfma_f32_16x16x32_bf16 v[120:123], v[56:59], v[44:47], v[120:123]
    ds_read_b64_tr_b16 v[90:91], v10 offset:8704
    s_waitcnt lgkmcnt(9)
    v_mfma_f32_16x16x32_bf16 v[136:139], v[56:59], v[48:51], v[136:139]
    ds_read_b128 v[72:75], v5 offset:43008
    s_waitcnt lgkmcnt(9)
    v_mfma_f32_16x16x32_bf16 v[152:155], v[56:59], v[52:55], v[152:155]
    ds_read_b128 v[76:79], v5 offset:45056
    s_waitcnt lgkmcnt(8)
    v_mfma_f32_16x16x32_bf16 v[108:111], v[60:63], v[40:43], v[108:111]
    ds_read_b128 v[80:83], v5 offset:47104
    v_mfma_f32_16x16x32_bf16 v[124:127], v[60:63], v[44:47], v[124:127]
    ds_read_b128 v[84:87], v5 offset:49152
    v_mfma_f32_16x16x32_bf16 v[140:143], v[60:63], v[48:51], v[140:143]
    v_mfma_f32_16x16x32_bf16 v[156:159], v[60:63], v[52:55], v[156:159]
    ds_read_b64_tr_b16 v[92:93], v11 offset:8192
    s_waitcnt lgkmcnt(9)
    v_mfma_f32_16x16x32_bf16 v[112:115], v[64:67], v[40:43], v[112:115]
    ds_read_b64_tr_b16 v[94:95], v11 offset:8704
    v_mfma_f32_16x16x32_bf16 v[128:131], v[64:67], v[44:47], v[128:131]
    ds_read_b64_tr_b16 v[96:97], v34 offset:8192
    v_mfma_f32_16x16x32_bf16 v[144:147], v[64:67], v[48:51], v[144:147]
    ds_read_b64_tr_b16 v[98:99], v34 offset:8704
    v_mfma_f32_16x16x32_bf16 v[160:163], v[64:67], v[52:55], v[160:163]
    ds_read_b64_tr_b16 v[100:101], v35 offset:8192
    s_waitcnt lgkmcnt(11)
    v_mfma_f32_16x16x32_bf16 v[116:119], v[68:71], v[40:43], v[116:119]
    ds_read_b64_tr_b16 v[102:103], v35 offset:8704
    v_mfma_f32_16x16x32_bf16 v[132:135], v[68:71], v[44:47], v[132:135]
    v_mfma_f32_16x16x32_bf16 v[148:151], v[68:71], v[48:51], v[148:151]
    v_mfma_f32_16x16x32_bf16 v[164:167], v[68:71], v[52:55], v[164:167]
    s_waitcnt lgkmcnt(9)
    v_mfma_f32_16x16x32_bf16 v[104:107], v[88:91], v[72:75], v[104:107]
    s_waitcnt lgkmcnt(8)
    v_mfma_f32_16x16x32_bf16 v[120:123], v[88:91], v[76:79], v[120:123]
    s_waitcnt lgkmcnt(7)
    v_mfma_f32_16x16x32_bf16 v[136:139], v[88:91], v[80:83], v[136:139]
    s_waitcnt lgkmcnt(0)
    s_barrier
    ds_read_b64_tr_b16 v[56:57], v10 offset:38912
    ds_read_b64_tr_b16 v[58:59], v10 offset:39424
    v_mfma_f32_16x16x32_bf16 v[152:155], v[88:91], v[84:87], v[152:155]
    ds_read_b128 v[40:43], v32 offset:20480
    v_mfma_f32_16x16x32_bf16 v[108:111], v[92:95], v[72:75], v[108:111]
    ds_read_b128 v[44:47], v32 offset:22528
    v_mfma_f32_16x16x32_bf16 v[124:127], v[92:95], v[76:79], v[124:127]
    ds_read_b128 v[48:51], v32 offset:24576
    v_mfma_f32_16x16x32_bf16 v[140:143], v[92:95], v[80:83], v[140:143]
    ds_read_b128 v[52:55], v32 offset:26624
    v_mfma_f32_16x16x32_bf16 v[156:159], v[92:95], v[84:87], v[156:159]
    ds_read_b64_tr_b16 v[60:61], v11 offset:38912
    v_mfma_f32_16x16x32_bf16 v[112:115], v[96:99], v[72:75], v[112:115]
    v_mfma_f32_16x16x32_bf16 v[128:131], v[96:99], v[76:79], v[128:131]
    ds_read_b64_tr_b16 v[62:63], v11 offset:39424
    v_mfma_f32_16x16x32_bf16 v[144:147], v[96:99], v[80:83], v[144:147]
    ds_read_b64_tr_b16 v[64:65], v34 offset:38912
    v_mfma_f32_16x16x32_bf16 v[160:163], v[96:99], v[84:87], v[160:163]
    ds_read_b64_tr_b16 v[66:67], v34 offset:39424
    v_mfma_f32_16x16x32_bf16 v[116:119], v[100:103], v[72:75], v[116:119]
    ds_read_b64_tr_b16 v[68:69], v35 offset:38912
    v_mfma_f32_16x16x32_bf16 v[132:135], v[100:103], v[76:79], v[132:135]
    ds_read_b64_tr_b16 v[70:71], v35 offset:39424
    v_mfma_f32_16x16x32_bf16 v[148:151], v[100:103], v[80:83], v[148:151]
    v_mfma_f32_16x16x32_bf16 v[164:167], v[100:103], v[84:87], v[164:167]
    s_waitcnt lgkmcnt(9)
    v_mfma_f32_16x16x32_bf16 v[104:107], v[56:59], v[40:43], v[104:107]
    ds_read_b64_tr_b16 v[88:89], v10 offset:51200
    s_waitcnt lgkmcnt(9)
    v_mfma_f32_16x16x32_bf16 v[120:123], v[56:59], v[44:47], v[120:123]
    ds_read_b64_tr_b16 v[90:91], v10 offset:51712
    s_waitcnt lgkmcnt(9)
    v_mfma_f32_16x16x32_bf16 v[136:139], v[56:59], v[48:51], v[136:139]
    ds_read_b128 v[72:75], v33 offset:20480
    s_waitcnt lgkmcnt(9)
    v_mfma_f32_16x16x32_bf16 v[152:155], v[56:59], v[52:55], v[152:155]
    ds_read_b128 v[76:79], v33 offset:22528
    s_waitcnt lgkmcnt(8)
    v_mfma_f32_16x16x32_bf16 v[108:111], v[60:63], v[40:43], v[108:111]
    ds_read_b128 v[80:83], v33 offset:24576
    v_mfma_f32_16x16x32_bf16 v[124:127], v[60:63], v[44:47], v[124:127]
    ds_read_b128 v[84:87], v33 offset:26624
    v_mfma_f32_16x16x32_bf16 v[140:143], v[60:63], v[48:51], v[140:143]
    v_mfma_f32_16x16x32_bf16 v[156:159], v[60:63], v[52:55], v[156:159]
    ds_read_b64_tr_b16 v[92:93], v11 offset:51200
    s_waitcnt lgkmcnt(9)
    v_mfma_f32_16x16x32_bf16 v[112:115], v[64:67], v[40:43], v[112:115]
    ds_read_b64_tr_b16 v[94:95], v11 offset:51712
    v_mfma_f32_16x16x32_bf16 v[128:131], v[64:67], v[44:47], v[128:131]
    ds_read_b64_tr_b16 v[96:97], v34 offset:51200
    v_mfma_f32_16x16x32_bf16 v[144:147], v[64:67], v[48:51], v[144:147]
    ds_read_b64_tr_b16 v[98:99], v34 offset:51712
    v_mfma_f32_16x16x32_bf16 v[160:163], v[64:67], v[52:55], v[160:163]
    ds_read_b64_tr_b16 v[100:101], v35 offset:51200
    s_waitcnt lgkmcnt(11)
    v_mfma_f32_16x16x32_bf16 v[116:119], v[68:71], v[40:43], v[116:119]
    ds_read_b64_tr_b16 v[102:103], v35 offset:51712
    v_mfma_f32_16x16x32_bf16 v[132:135], v[68:71], v[44:47], v[132:135]
    v_mfma_f32_16x16x32_bf16 v[148:151], v[68:71], v[48:51], v[148:151]
    v_mfma_f32_16x16x32_bf16 v[164:167], v[68:71], v[52:55], v[164:167]
    s_waitcnt lgkmcnt(9)
    v_mfma_f32_16x16x32_bf16 v[104:107], v[88:91], v[72:75], v[104:107]
    s_waitcnt lgkmcnt(8)
    v_mfma_f32_16x16x32_bf16 v[120:123], v[88:91], v[76:79], v[120:123]
    s_waitcnt lgkmcnt(7)
    v_mfma_f32_16x16x32_bf16 v[136:139], v[88:91], v[80:83], v[136:139]
    s_waitcnt lgkmcnt(0)
    s_barrier
    ds_read_b64_tr_b16 v[56:57], v6 offset:18432
    ds_read_b64_tr_b16 v[58:59], v6 offset:18944
    v_mfma_f32_16x16x32_bf16 v[152:155], v[88:91], v[84:87], v[152:155]
    ds_read_b128 v[40:43], v4 offset:0
    v_mfma_f32_16x16x32_bf16 v[108:111], v[92:95], v[72:75], v[108:111]
    ds_read_b128 v[44:47], v4 offset:2048
    v_mfma_f32_16x16x32_bf16 v[124:127], v[92:95], v[76:79], v[124:127]
    ds_read_b128 v[48:51], v4 offset:4096
    v_mfma_f32_16x16x32_bf16 v[140:143], v[92:95], v[80:83], v[140:143]
    ds_read_b128 v[52:55], v4 offset:6144
    v_mfma_f32_16x16x32_bf16 v[156:159], v[92:95], v[84:87], v[156:159]
    ds_read_b64_tr_b16 v[60:61], v7 offset:18432
    v_mfma_f32_16x16x32_bf16 v[112:115], v[96:99], v[72:75], v[112:115]
    v_mfma_f32_16x16x32_bf16 v[128:131], v[96:99], v[76:79], v[128:131]
    ds_read_b64_tr_b16 v[62:63], v7 offset:18944
    v_mfma_f32_16x16x32_bf16 v[144:147], v[96:99], v[80:83], v[144:147]
    ds_read_b64_tr_b16 v[64:65], v8 offset:18432
    v_mfma_f32_16x16x32_bf16 v[160:163], v[96:99], v[84:87], v[160:163]
    ds_read_b64_tr_b16 v[66:67], v8 offset:18944
    v_mfma_f32_16x16x32_bf16 v[116:119], v[100:103], v[72:75], v[116:119]
    ds_read_b64_tr_b16 v[68:69], v9 offset:18432
    v_mfma_f32_16x16x32_bf16 v[132:135], v[100:103], v[76:79], v[132:135]
    ds_read_b64_tr_b16 v[70:71], v9 offset:18944
    v_mfma_f32_16x16x32_bf16 v[148:151], v[100:103], v[80:83], v[148:151]
    v_mfma_f32_16x16x32_bf16 v[164:167], v[100:103], v[84:87], v[164:167]
    s_waitcnt lgkmcnt(9)
    v_mfma_f32_16x16x32_bf16 v[104:107], v[56:59], v[40:43], v[104:107]
    ds_read_b64_tr_b16 v[88:89], v6 offset:30720
    s_waitcnt lgkmcnt(9)
    v_mfma_f32_16x16x32_bf16 v[120:123], v[56:59], v[44:47], v[120:123]
    ds_read_b64_tr_b16 v[90:91], v6 offset:31232
    s_waitcnt lgkmcnt(9)
    v_mfma_f32_16x16x32_bf16 v[136:139], v[56:59], v[48:51], v[136:139]
    ds_read_b128 v[72:75], v5 offset:0
    s_waitcnt lgkmcnt(9)
    v_mfma_f32_16x16x32_bf16 v[152:155], v[56:59], v[52:55], v[152:155]
    ds_read_b128 v[76:79], v5 offset:2048
    s_waitcnt lgkmcnt(8)
    v_mfma_f32_16x16x32_bf16 v[108:111], v[60:63], v[40:43], v[108:111]
    ds_read_b128 v[80:83], v5 offset:4096
    v_mfma_f32_16x16x32_bf16 v[124:127], v[60:63], v[44:47], v[124:127]
    ds_read_b128 v[84:87], v5 offset:6144
    v_mfma_f32_16x16x32_bf16 v[140:143], v[60:63], v[48:51], v[140:143]
    v_mfma_f32_16x16x32_bf16 v[156:159], v[60:63], v[52:55], v[156:159]
    ds_read_b64_tr_b16 v[92:93], v7 offset:30720
    s_waitcnt lgkmcnt(9)
    v_mfma_f32_16x16x32_bf16 v[112:115], v[64:67], v[40:43], v[112:115]
    ds_read_b64_tr_b16 v[94:95], v7 offset:31232
    v_mfma_f32_16x16x32_bf16 v[128:131], v[64:67], v[44:47], v[128:131]
    ds_read_b64_tr_b16 v[96:97], v8 offset:30720
    v_mfma_f32_16x16x32_bf16 v[144:147], v[64:67], v[48:51], v[144:147]
    ds_read_b64_tr_b16 v[98:99], v8 offset:31232
    v_mfma_f32_16x16x32_bf16 v[160:163], v[64:67], v[52:55], v[160:163]
    ds_read_b64_tr_b16 v[100:101], v9 offset:30720
    s_waitcnt lgkmcnt(11)
    v_mfma_f32_16x16x32_bf16 v[116:119], v[68:71], v[40:43], v[116:119]
    ds_read_b64_tr_b16 v[102:103], v9 offset:31232
    v_mfma_f32_16x16x32_bf16 v[132:135], v[68:71], v[44:47], v[132:135]
    v_mfma_f32_16x16x32_bf16 v[148:151], v[68:71], v[48:51], v[148:151]
    v_mfma_f32_16x16x32_bf16 v[164:167], v[68:71], v[52:55], v[164:167]
    s_waitcnt lgkmcnt(9)
    v_mfma_f32_16x16x32_bf16 v[104:107], v[88:91], v[72:75], v[104:107]
    s_waitcnt lgkmcnt(8)
    v_mfma_f32_16x16x32_bf16 v[120:123], v[88:91], v[76:79], v[120:123]
    s_waitcnt lgkmcnt(7)
    v_mfma_f32_16x16x32_bf16 v[136:139], v[88:91], v[80:83], v[136:139]
    s_waitcnt lgkmcnt(0)
    s_barrier
    s_setprio 1
    ds_read_b64_tr_b16 v[56:57], v6 offset:61440
    ds_read_b64_tr_b16 v[58:59], v6 offset:61952
    v_mfma_f32_16x16x32_bf16 v[152:155], v[88:91], v[84:87], v[152:155]
    ds_read_b128 v[40:43], v4 offset:43008
    v_mfma_f32_16x16x32_bf16 v[108:111], v[92:95], v[72:75], v[108:111]
    ds_read_b128 v[44:47], v4 offset:45056
    v_mfma_f32_16x16x32_bf16 v[124:127], v[92:95], v[76:79], v[124:127]
    ds_read_b128 v[48:51], v4 offset:47104
    v_mfma_f32_16x16x32_bf16 v[140:143], v[92:95], v[80:83], v[140:143]
    ds_read_b128 v[52:55], v4 offset:49152
    v_mfma_f32_16x16x32_bf16 v[156:159], v[92:95], v[84:87], v[156:159]
    ds_read_b64_tr_b16 v[60:61], v7 offset:61440
    v_mfma_f32_16x16x32_bf16 v[112:115], v[96:99], v[72:75], v[112:115]
    v_mfma_f32_16x16x32_bf16 v[128:131], v[96:99], v[76:79], v[128:131]
    ds_read_b64_tr_b16 v[62:63], v7 offset:61952
    v_mfma_f32_16x16x32_bf16 v[144:147], v[96:99], v[80:83], v[144:147]
    ds_read_b64_tr_b16 v[64:65], v8 offset:61440
    v_mfma_f32_16x16x32_bf16 v[160:163], v[96:99], v[84:87], v[160:163]
    ds_read_b64_tr_b16 v[66:67], v8 offset:61952
    v_mfma_f32_16x16x32_bf16 v[116:119], v[100:103], v[72:75], v[116:119]
    ds_read_b64_tr_b16 v[68:69], v9 offset:61440
    v_mfma_f32_16x16x32_bf16 v[132:135], v[100:103], v[76:79], v[132:135]
    ds_read_b64_tr_b16 v[70:71], v9 offset:61952
    v_mfma_f32_16x16x32_bf16 v[148:151], v[100:103], v[80:83], v[148:151]
    v_mfma_f32_16x16x32_bf16 v[164:167], v[100:103], v[84:87], v[164:167]
    s_waitcnt lgkmcnt(9)
    v_mfma_f32_16x16x32_bf16 v[104:107], v[56:59], v[40:43], v[104:107]
    ds_read_b64_tr_b16 v[88:89], v10 offset:8192
    s_waitcnt lgkmcnt(9)
    v_mfma_f32_16x16x32_bf16 v[120:123], v[56:59], v[44:47], v[120:123]
    ds_read_b64_tr_b16 v[90:91], v10 offset:8704
    s_waitcnt lgkmcnt(9)
    v_mfma_f32_16x16x32_bf16 v[136:139], v[56:59], v[48:51], v[136:139]
    ds_read_b128 v[72:75], v5 offset:43008
    s_waitcnt lgkmcnt(9)
    v_mfma_f32_16x16x32_bf16 v[152:155], v[56:59], v[52:55], v[152:155]
    ds_read_b128 v[76:79], v5 offset:45056
    s_waitcnt lgkmcnt(8)
    v_mfma_f32_16x16x32_bf16 v[108:111], v[60:63], v[40:43], v[108:111]
    ds_read_b128 v[80:83], v5 offset:47104
    v_mfma_f32_16x16x32_bf16 v[124:127], v[60:63], v[44:47], v[124:127]
    ds_read_b128 v[84:87], v5 offset:49152
    v_mfma_f32_16x16x32_bf16 v[140:143], v[60:63], v[48:51], v[140:143]
    ds_read_b32 v37, v36 offset:192
    v_mfma_f32_16x16x32_bf16 v[156:159], v[60:63], v[52:55], v[156:159]
    ds_read_b64_tr_b16 v[92:93], v11 offset:8192
    s_waitcnt lgkmcnt(10)
    v_mfma_f32_16x16x32_bf16 v[112:115], v[64:67], v[40:43], v[112:115]
    ds_read_b64_tr_b16 v[94:95], v11 offset:8704
    v_mfma_f32_16x16x32_bf16 v[128:131], v[64:67], v[44:47], v[128:131]
    ds_read_b64_tr_b16 v[96:97], v34 offset:8192
    v_mfma_f32_16x16x32_bf16 v[144:147], v[64:67], v[48:51], v[144:147]
    ds_read_b64_tr_b16 v[98:99], v34 offset:8704
    v_mfma_f32_16x16x32_bf16 v[160:163], v[64:67], v[52:55], v[160:163]
    ds_read_b64_tr_b16 v[100:101], v35 offset:8192
    s_waitcnt lgkmcnt(12)
    v_mfma_f32_16x16x32_bf16 v[116:119], v[68:71], v[40:43], v[116:119]
    ds_read_b64_tr_b16 v[102:103], v35 offset:8704
    v_mfma_f32_16x16x32_bf16 v[132:135], v[68:71], v[44:47], v[132:135]
    v_mov_b32 v38, 1
    s_mov_b64 exec, 1
    ds_add_u32 v36, v38 offset:120
    s_mov_b64 exec, -1
    v_mfma_f32_16x16x32_bf16 v[148:151], v[68:71], v[48:51], v[148:151]
    v_mfma_f32_16x16x32_bf16 v[164:167], v[68:71], v[52:55], v[164:167]
    s_waitcnt lgkmcnt(7)
    v_readfirstlane_b32 s36, v37
    s_nop 0
    s_cmp_lt_u32 s36, 4
    s_cbranch_scc1 FFN4_LF7
FFN4_LF7_OK:
    v_mfma_f32_16x16x32_bf16 v[104:107], v[88:91], v[72:75], v[104:107]
    ds_read_b64_tr_b16 v[56:57], v10 offset:38912
    v_mfma_f32_16x16x32_bf16 v[120:123], v[88:91], v[76:79], v[120:123]
    ds_read_b64_tr_b16 v[58:59], v10 offset:39424
    v_mfma_f32_16x16x32_bf16 v[136:139], v[88:91], v[80:83], v[136:139]
    ds_read_b128 v[40:43], v32 offset:20480
    v_mfma_f32_16x16x32_bf16 v[152:155], v[88:91], v[84:87], v[152:155]
    ds_read_b128 v[44:47], v32 offset:22528
    s_waitcnt lgkmcnt(9)
    v_mfma_f32_16x16x32_bf16 v[108:111], v[92:95], v[72:75], v[108:111]
    v_mfma_f32_16x16x32_bf16 v[124:127], v[92:95], v[76:79], v[124:127]
    ds_read_b128 v[48:51], v32 offset:24576
    v_mfma_f32_16x16x32_bf16 v[140:143], v[92:95], v[80:83], v[140:143]
    ds_read_b128 v[52:55], v32 offset:26624
    v_mfma_f32_16x16x32_bf16 v[156:159], v[92:95], v[84:87], v[156:159]
    ds_read_b64_tr_b16 v[60:61], v11 offset:38912
    s_waitcnt lgkmcnt(10)
    v_mfma_f32_16x16x32_bf16 v[112:115], v[96:99], v[72:75], v[112:115]
    ds_read_b64_tr_b16 v[62:63], v11 offset:39424
    v_mfma_f32_16x16x32_bf16 v[128:131], v[96:99], v[76:79], v[128:131]
    v_mfma_f32_16x16x32_bf16 v[144:147], v[96:99], v[80:83], v[144:147]
    ds_read_b64_tr_b16 v[64:65], v34 offset:38912
    v_mfma_f32_16x16x32_bf16 v[160:163], v[96:99], v[84:87], v[160:163]
    ds_read_b64_tr_b16 v[66:67], v34 offset:39424
    s_waitcnt lgkmcnt(11)
    v_mfma_f32_16x16x32_bf16 v[116:119], v[100:103], v[72:75], v[116:119]
    ds_read_b64_tr_b16 v[68:69], v35 offset:38912
    v_mfma_f32_16x16x32_bf16 v[132:135], v[100:103], v[76:79], v[132:135]
    ds_read_b64_tr_b16 v[70:71], v35 offset:39424
    v_mfma_f32_16x16x32_bf16 v[148:151], v[100:103], v[80:83], v[148:151]
    v_mfma_f32_16x16x32_bf16 v[164:167], v[100:103], v[84:87], v[164:167]
    s_waitcnt lgkmcnt(9)
    v_mfma_f32_16x16x32_bf16 v[104:107], v[56:59], v[40:43], v[104:107]
    ds_read_b64_tr_b16 v[88:89], v10 offset:51200
    s_waitcnt lgkmcnt(9)
    v_mfma_f32_16x16x32_bf16 v[120:123], v[56:59], v[44:47], v[120:123]
    ds_read_b64_tr_b16 v[90:91], v10 offset:51712
    s_waitcnt lgkmcnt(9)
    v_mfma_f32_16x16x32_bf16 v[136:139], v[56:59], v[48:51], v[136:139]
    ds_read_b128 v[72:75], v33 offset:20480
    s_waitcnt lgkmcnt(9)
    v_mfma_f32_16x16x32_bf16 v[152:155], v[56:59], v[52:55], v[152:155]
    ds_read_b128 v[76:79], v33 offset:22528
    s_waitcnt lgkmcnt(8)
    v_mfma_f32_16x16x32_bf16 v[108:111], v[60:63], v[40:43], v[108:111]
    ds_read_b128 v[80:83], v33 offset:24576
    v_mfma_f32_16x16x32_bf16 v[124:127], v[60:63], v[44:47], v[124:127]
    ds_read_b128 v[84:87], v33 offset:26624
    v_mfma_f32_16x16x32_bf16 v[140:143], v[60:63], v[48:51], v[140:143]
    ds_read_b64_tr_b16 v[92:93], v11 offset:51200
    v_mfma_f32_16x16x32_bf16 v[156:159], v[60:63], v[52:55], v[156:159]
    s_waitcnt lgkmcnt(9)
    v_mfma_f32_16x16x32_bf16 v[112:115], v[64:67], v[40:43], v[112:115]
    ds_read_b64_tr_b16 v[94:95], v11 offset:51712
    v_mfma_f32_16x16x32_bf16 v[128:131], v[64:67], v[44:47], v[128:131]
    ds_read_b64_tr_b16 v[96:97], v34 offset:51200
    v_mfma_f32_16x16x32_bf16 v[144:147], v[64:67], v[48:51], v[144:147]
    ds_read_b64_tr_b16 v[98:99], v34 offset:51712
    v_mfma_f32_16x16x32_bf16 v[160:163], v[64:67], v[52:55], v[160:163]
    ds_read_b64_tr_b16 v[100:101], v35 offset:51200
    s_waitcnt lgkmcnt(11)
    v_mfma_f32_16x16x32_bf16 v[116:119], v[68:71], v[40:43], v[116:119]
    ds_read_b64_tr_b16 v[102:103], v35 offset:51712
    v_mfma_f32_16x16x32_bf16 v[132:135], v[68:71], v[44:47], v[132:135]
    v_mov_b32 v38, 1
    s_mov_b64 exec, 1
    ds_add_u32 v36, v38 offset:124
    s_mov_b64 exec, -1
    v_mfma_f32_16x16x32_bf16 v[148:151], v[68:71], v[48:51], v[148:151]
    v_mfma_f32_16x16x32_bf16 v[164:167], v[68:71], v[52:55], v[164:167]
    s_waitcnt lgkmcnt(10)
    v_mfma_f32_16x16x32_bf16 v[104:107], v[88:91], v[72:75], v[104:107]
    s_waitcnt lgkmcnt(9)
    v_mfma_f32_16x16x32_bf16 v[120:123], v[88:91], v[76:79], v[120:123]
    s_waitcnt lgkmcnt(8)
    v_mfma_f32_16x16x32_bf16 v[136:139], v[88:91], v[80:83], v[136:139]
    s_waitcnt lgkmcnt(7)
    v_mfma_f32_16x16x32_bf16 v[152:155], v[88:91], v[84:87], v[152:155]
    s_waitcnt lgkmcnt(5)
    v_mfma_f32_16x16x32_bf16 v[108:111], v[92:95], v[72:75], v[108:111]
    v_mfma_f32_16x16x32_bf16 v[124:127], v[92:95], v[76:79], v[124:127]
    v_mfma_f32_16x16x32_bf16 v[140:143], v[92:95], v[80:83], v[140:143]
    v_mfma_f32_16x16x32_bf16 v[156:159], v[92:95], v[84:87], v[156:159]
    s_waitcnt lgkmcnt(3)
    v_mfma_f32_16x16x32_bf16 v[112:115], v[96:99], v[72:75], v[112:115]
    v_mfma_f32_16x16x32_bf16 v[128:131], v[96:99], v[76:79], v[128:131]
    v_mfma_f32_16x16x32_bf16 v[144:147], v[96:99], v[80:83], v[144:147]
    v_mfma_f32_16x16x32_bf16 v[160:163], v[96:99], v[84:87], v[160:163]
    s_waitcnt lgkmcnt(1)
    v_mfma_f32_16x16x32_bf16 v[116:119], v[100:103], v[72:75], v[116:119]
    v_mfma_f32_16x16x32_bf16 v[132:135], v[100:103], v[76:79], v[132:135]
    ds_read_b32 v37, v36 offset:8
    v_mfma_f32_16x16x32_bf16 v[148:151], v[100:103], v[80:83], v[148:151]
    v_mfma_f32_16x16x32_bf16 v[164:167], v[100:103], v[84:87], v[164:167]
    s_setprio 0
    s_waitcnt lgkmcnt(0)
    v_readfirstlane_b32 s36, v37
    s_nop 0
    s_cmp_lt_u32 s36, 4
    s_cbranch_scc1 FFN4_SSP
FFN4_SSP_OK:
    s_mov_b32 s60, 3216550459
    s_mov_b32 s61, 3216550459
    s_lshl_b32 s36, s35, 10
    s_add_u32 s36, s36, 159744
    v_lshl_add_u32 v36, v2, 4, s36
    s_add_u32 s42, s67, 162048
    v_lshl_add_u32 v37, v3, 4, s42
    ds_read_b128 v[72:75], v36
    ds_read_b128 v[12:15], v37 offset:0
    ds_read_b128 v[16:19], v37 offset:64
    ds_read_b128 v[20:23], v37 offset:128
    ds_read_b128 v[24:27], v37 offset:192
    ds_read_b128 v[76:79], v36 offset:256
    ds_read_b128 v[80:83], v36 offset:512
    ds_read_b128 v[84:87], v36 offset:768
    s_waitcnt lgkmcnt(0)
    v_pk_mul_f32 v[74:75], s[60:61], v[74:75]
    v_pk_mul_f32 v[78:79], s[60:61], v[78:79]
    v_pk_mul_f32 v[82:83], s[60:61], v[82:83]
    v_pk_mul_f32 v[86:87], s[60:61], v[86:87]
    v_pk_fma_f32 v[104:105], v[12:13], v[72:73], v[104:105]
    v_pk_fma_f32 v[106:107], v[14:15], v[72:73], v[106:107]
    v_pk_mul_f32 v[104:105], v[104:105], v[74:75]
    v_pk_mul_f32 v[106:107], v[106:107], v[74:75]
    v_exp_f32 v40, v104
    v_exp_f32 v41, v105
    v_exp_f32 v42, v106
    v_exp_f32 v43, v107
    v_pk_fma_f32 v[108:109], v[16:17], v[72:73], v[108:109]
    v_pk_fma_f32 v[110:111], v[18:19], v[72:73], v[110:111]
    v_pk_mul_f32 v[108:109], v[108:109], v[74:75]
    v_pk_mul_f32 v[110:111], v[110:111], v[74:75]
    v_exp_f32 v44, v108
    v_exp_f32 v45, v109
    v_exp_f32 v46, v110
    v_exp_f32 v47, v111
    v_pk_fma_f32 v[112:113], v[20:21], v[72:73], v[112:113]
    v_pk_fma_f32 v[114:115], v[22:23], v[72:73], v[114:115]
    v_pk_mul_f32 v[112:113], v[112:113], v[74:75]
    v_pk_mul_f32 v[114:115], v[114:115], v[74:75]
    v_exp_f32 v48, v112
    v_exp_f32 v49, v113
    v_exp_f32 v50, v114
    v_exp_f32 v51, v115
    v_pk_fma_f32 v[116:117], v[24:25], v[72:73], v[116:117]
    v_pk_fma_f32 v[118:119], v[26:27], v[72:73], v[118:119]
    v_pk_mul_f32 v[116:117], v[116:117], v[74:75]
    v_pk_mul_f32 v[118:119], v[118:119], v[74:75]
    v_exp_f32 v52, v116
    v_exp_f32 v53, v117
    v_exp_f32 v54, v118
    v_exp_f32 v55, v119
    v_pk_fma_f32 v[40:41], v[40:41], s[60:61], s[60:61]
    v_pk_fma_f32 v[42:43], v[42:43], s[60:61], s[60:61]
    v_rcp_f32 v40, v40
    v_rcp_f32 v41, v41
    v_rcp_f32 v42, v42
    v_rcp_f32 v43, v43
    v_pk_fma_f32 v[44:45], v[44:45], s[60:61], s[60:61]
    v_pk_fma_f32 v[46:47], v[46:47], s[60:61], s[60:61]
    v_rcp_f32 v44, v44
    v_rcp_f32 v45, v45
    v_rcp_f32 v46, v46
    v_rcp_f32 v47, v47
    v_pk_fma_f32 v[48:49], v[48:49], s[60:61], s[60:61]
    v_pk_fma_f32 v[50:51], v[50:51], s[60:61], s[60:61]
    v_rcp_f32 v48, v48
    v_rcp_f32 v49, v49
    v_rcp_f32 v50, v50
    v_rcp_f32 v51, v51
    v_pk_fma_f32 v[52:53], v[52:53], s[60:61], s[60:61]
    v_pk_fma_f32 v[54:55], v[54:55], s[60:61], s[60:61]
    v_rcp_f32 v52, v52
    v_rcp_f32 v53, v53
    v_rcp_f32 v54, v54
    v_rcp_f32 v55, v55
    v_pk_mul_f32 v[40:41], v[104:105], v[40:41]
    v_pk_mul_f32 v[42:43], v[106:107], v[42:43]
    v_pk_mul_f32 v[44:45], v[108:109], v[44:45]
    v_pk_mul_f32 v[46:47], v[110:111], v[46:47]
    v_pk_mul_f32 v[48:49], v[112:113], v[48:49]
    v_pk_mul_f32 v[50:51], v[114:115], v[50:51]
    v_pk_mul_f32 v[52:53], v[116:117], v[52:53]
    v_pk_mul_f32 v[54:55], v[118:119], v[54:55]
    v_cvt_pk_bf16_f32 v104, v40, v41
    v_cvt_pk_bf16_f32 v105, v42, v43
    v_cvt_pk_bf16_f32 v106, v44, v45
    v_cvt_pk_bf16_f32 v107, v46, v47
    v_cvt_pk_bf16_f32 v108, v48, v49
    v_cvt_pk_bf16_f32 v109, v50, v51
    v_cvt_pk_bf16_f32 v110, v52, v53
    v_cvt_pk_bf16_f32 v111, v54, v55
    buffer_store_dwordx4 v[104:107], v1, s[16:19], s51 offen sc1
    buffer_store_dwordx4 v[108:111], v1, s[16:19], s51 offen offset:1024 sc1
    s_add_u32 s51, s51, 73728
    v_pk_fma_f32 v[120:121], v[12:13], v[76:77], v[120:121]
    v_pk_fma_f32 v[122:123], v[14:15], v[76:77], v[122:123]
    v_pk_mul_f32 v[120:121], v[120:121], v[78:79]
    v_pk_mul_f32 v[122:123], v[122:123], v[78:79]
    v_exp_f32 v40, v120
    v_exp_f32 v41, v121
    v_exp_f32 v42, v122
    v_exp_f32 v43, v123
    v_pk_fma_f32 v[124:125], v[16:17], v[76:77], v[124:125]
    v_pk_fma_f32 v[126:127], v[18:19], v[76:77], v[126:127]
    v_pk_mul_f32 v[124:125], v[124:125], v[78:79]
    v_pk_mul_f32 v[126:127], v[126:127], v[78:79]
    v_exp_f32 v44, v124
    v_exp_f32 v45, v125
    v_exp_f32 v46, v126
    v_exp_f32 v47, v127
    v_pk_fma_f32 v[128:129], v[20:21], v[76:77], v[128:129]
    v_pk_fma_f32 v[130:131], v[22:23], v[76:77], v[130:131]
    v_pk_mul_f32 v[128:129], v[128:129], v[78:79]
    v_pk_mul_f32 v[130:131], v[130:131], v[78:79]
    v_exp_f32 v48, v128
    v_exp_f32 v49, v129
    v_exp_f32 v50, v130
    v_exp_f32 v51, v131
    v_pk_fma_f32 v[132:133], v[24:25], v[76:77], v[132:133]
    v_pk_fma_f32 v[134:135], v[26:27], v[76:77], v[134:135]
    v_pk_mul_f32 v[132:133], v[132:133], v[78:79]
    v_pk_mul_f32 v[134:135], v[134:135], v[78:79]
    v_exp_f32 v52, v132
    v_exp_f32 v53, v133
    v_exp_f32 v54, v134
    v_exp_f32 v55, v135
    v_pk_fma_f32 v[40:41], v[40:41], s[60:61], s[60:61]
    v_pk_fma_f32 v[42:43], v[42:43], s[60:61], s[60:61]
    v_rcp_f32 v40, v40
    v_rcp_f32 v41, v41
    v_rcp_f32 v42, v42
    v_rcp_f32 v43, v43
    v_pk_fma_f32 v[44:45], v[44:45], s[60:61], s[60:61]
    v_pk_fma_f32 v[46:47], v[46:47], s[60:61], s[60:61]
    v_rcp_f32 v44, v44
    v_rcp_f32 v45, v45
    v_rcp_f32 v46, v46
    v_rcp_f32 v47, v47
    v_pk_fma_f32 v[48:49], v[48:49], s[60:61], s[60:61]
    v_pk_fma_f32 v[50:51], v[50:51], s[60:61], s[60:61]
    v_rcp_f32 v48, v48
    v_rcp_f32 v49, v49
    v_rcp_f32 v50, v50
    v_rcp_f32 v51, v51
    v_pk_fma_f32 v[52:53], v[52:53], s[60:61], s[60:61]
    v_pk_fma_f32 v[54:55], v[54:55], s[60:61], s[60:61]
    v_rcp_f32 v52, v52
    v_rcp_f32 v53, v53
    v_rcp_f32 v54, v54
    v_rcp_f32 v55, v55
    v_pk_mul_f32 v[40:41], v[120:121], v[40:41]
    v_pk_mul_f32 v[42:43], v[122:123], v[42:43]
    v_pk_mul_f32 v[44:45], v[124:125], v[44:45]
    v_pk_mul_f32 v[46:47], v[126:127], v[46:47]
    v_pk_mul_f32 v[48:49], v[128:129], v[48:49]
    v_pk_mul_f32 v[50:51], v[130:131], v[50:51]
    v_pk_mul_f32 v[52:53], v[132:133], v[52:53]
    v_pk_mul_f32 v[54:55], v[134:135], v[54:55]
    v_cvt_pk_bf16_f32 v120, v40, v41
    v_cvt_pk_bf16_f32 v121, v42, v43
    v_cvt_pk_bf16_f32 v122, v44, v45
    v_cvt_pk_bf16_f32 v123, v46, v47
    v_cvt_pk_bf16_f32 v124, v48, v49
    v_cvt_pk_bf16_f32 v125, v50, v51
    v_cvt_pk_bf16_f32 v126, v52, v53
    v_cvt_pk_bf16_f32 v127, v54, v55
    buffer_store_dwordx4 v[120:123], v1, s[16:19], s51 offen sc1
    buffer_store_dwordx4 v[124:127], v1, s[16:19], s51 offen offset:1024 sc1
    s_add_u32 s51, s51, 73728
    v_pk_fma_f32 v[136:137], v[12:13], v[80:81], v[136:137]
    v_pk_fma_f32 v[138:139], v[14:15], v[80:81], v[138:139]
    v_pk_mul_f32 v[136:137], v[136:137], v[82:83]
    v_pk_mul_f32 v[138:139], v[138:139], v[82:83]
    v_exp_f32 v40, v136
    v_exp_f32 v41, v137
    v_exp_f32 v42, v138
    v_exp_f32 v43, v139
    v_pk_fma_f32 v[140:141], v[16:17], v[80:81], v[140:141]
    v_pk_fma_f32 v[142:143], v[18:19], v[80:81], v[142:143]
    v_pk_mul_f32 v[140:141], v[140:141], v[82:83]
    v_pk_mul_f32 v[142:143], v[142:143], v[82:83]
    v_exp_f32 v44, v140
    v_exp_f32 v45, v141
    v_exp_f32 v46, v142
    v_exp_f32 v47, v143
    v_pk_fma_f32 v[144:145], v[20:21], v[80:81], v[144:145]
    v_pk_fma_f32 v[146:147], v[22:23], v[80:81], v[146:147]
    v_pk_mul_f32 v[144:145], v[144:145], v[82:83]
    v_pk_mul_f32 v[146:147], v[146:147], v[82:83]
    v_exp_f32 v48, v144
    v_exp_f32 v49, v145
    v_exp_f32 v50, v146
    v_exp_f32 v51, v147
    v_pk_fma_f32 v[148:149], v[24:25], v[80:81], v[148:149]
    v_pk_fma_f32 v[150:151], v[26:27], v[80:81], v[150:151]
    v_pk_mul_f32 v[148:149], v[148:149], v[82:83]
    v_pk_mul_f32 v[150:151], v[150:151], v[82:83]
    v_exp_f32 v52, v148
    v_exp_f32 v53, v149
    v_exp_f32 v54, v150
    v_exp_f32 v55, v151
    v_pk_fma_f32 v[40:41], v[40:41], s[60:61], s[60:61]
    v_pk_fma_f32 v[42:43], v[42:43], s[60:61], s[60:61]
    v_rcp_f32 v40, v40
    v_rcp_f32 v41, v41
    v_rcp_f32 v42, v42
    v_rcp_f32 v43, v43
    v_pk_fma_f32 v[44:45], v[44:45], s[60:61], s[60:61]
    v_pk_fma_f32 v[46:47], v[46:47], s[60:61], s[60:61]
    v_rcp_f32 v44, v44
    v_rcp_f32 v45, v45
    v_rcp_f32 v46, v46
    v_rcp_f32 v47, v47
    v_pk_fma_f32 v[48:49], v[48:49], s[60:61], s[60:61]
    v_pk_fma_f32 v[50:51], v[50:51], s[60:61], s[60:61]
    v_rcp_f32 v48, v48
    v_rcp_f32 v49, v49
    v_rcp_f32 v50, v50
    v_rcp_f32 v51, v51
    v_pk_fma_f32 v[52:53], v[52:53], s[60:61], s[60:61]
    v_pk_fma_f32 v[54:55], v[54:55], s[60:61], s[60:61]
    v_rcp_f32 v52, v52
    v_rcp_f32 v53, v53
    v_rcp_f32 v54, v54
    v_rcp_f32 v55, v55
    v_pk_mul_f32 v[40:41], v[136:137], v[40:41]
    v_pk_mul_f32 v[42:43], v[138:139], v[42:43]
    v_pk_mul_f32 v[44:45], v[140:141], v[44:45]
    v_pk_mul_f32 v[46:47], v[142:143], v[46:47]
    v_pk_mul_f32 v[48:49], v[144:145], v[48:49]
    v_pk_mul_f32 v[50:51], v[146:147], v[50:51]
    v_pk_mul_f32 v[52:53], v[148:149], v[52:53]
    v_pk_mul_f32 v[54:55], v[150:151], v[54:55]
    v_cvt_pk_bf16_f32 v136, v40, v41
    v_cvt_pk_bf16_f32 v137, v42, v43
    v_cvt_pk_bf16_f32 v138, v44, v45
    v_cvt_pk_bf16_f32 v139, v46, v47
    v_cvt_pk_bf16_f32 v140, v48, v49
    v_cvt_pk_bf16_f32 v141, v50, v51
    v_cvt_pk_bf16_f32 v142, v52, v53
    v_cvt_pk_bf16_f32 v143, v54, v55
    buffer_store_dwordx4 v[136:139], v1, s[16:19], s51 offen sc1
    buffer_store_dwordx4 v[140:143], v1, s[16:19], s51 offen offset:1024 sc1
    s_add_u32 s51, s51, 73728
    v_pk_fma_f32 v[152:153], v[12:13], v[84:85], v[152:153]
    v_pk_fma_f32 v[154:155], v[14:15], v[84:85], v[154:155]
    v_pk_mul_f32 v[152:153], v[152:153], v[86:87]
    v_pk_mul_f32 v[154:155], v[154:155], v[86:87]
    v_exp_f32 v40, v152
    v_exp_f32 v41, v153
    v_exp_f32 v42, v154
    v_exp_f32 v43, v155
    v_pk_fma_f32 v[156:157], v[16:17], v[84:85], v[156:157]
    v_pk_fma_f32 v[158:159], v[18:19], v[84:85], v[158:159]
    v_pk_mul_f32 v[156:157], v[156:157], v[86:87]
    v_pk_mul_f32 v[158:159], v[158:159], v[86:87]
    v_exp_f32 v44, v156
    v_exp_f32 v45, v157
    v_exp_f32 v46, v158
    v_exp_f32 v47, v159
    v_pk_fma_f32 v[160:161], v[20:21], v[84:85], v[160:161]
    v_pk_fma_f32 v[162:163], v[22:23], v[84:85], v[162:163]
    v_pk_mul_f32 v[160:161], v[160:161], v[86:87]
    v_pk_mul_f32 v[162:163], v[162:163], v[86:87]
    v_exp_f32 v48, v160
    v_exp_f32 v49, v161
    v_exp_f32 v50, v162
    v_exp_f32 v51, v163
    v_pk_fma_f32 v[164:165], v[24:25], v[84:85], v[164:165]
    v_pk_fma_f32 v[166:167], v[26:27], v[84:85], v[166:167]
    v_pk_mul_f32 v[164:165], v[164:165], v[86:87]
    v_pk_mul_f32 v[166:167], v[166:167], v[86:87]
    v_exp_f32 v52, v164
    v_exp_f32 v53, v165
    v_exp_f32 v54, v166
    v_exp_f32 v55, v167
    v_pk_fma_f32 v[40:41], v[40:41], s[60:61], s[60:61]
    v_pk_fma_f32 v[42:43], v[42:43], s[60:61], s[60:61]
    v_rcp_f32 v40, v40
    v_rcp_f32 v41, v41
    v_rcp_f32 v42, v42
    v_rcp_f32 v43, v43
    v_pk_fma_f32 v[44:45], v[44:45], s[60:61], s[60:61]
    v_pk_fma_f32 v[46:47], v[46:47], s[60:61], s[60:61]
    v_rcp_f32 v44, v44
    v_rcp_f32 v45, v45
    v_rcp_f32 v46, v46
    v_rcp_f32 v47, v47
    v_pk_fma_f32 v[48:49], v[48:49], s[60:61], s[60:61]
    v_pk_fma_f32 v[50:51], v[50:51], s[60:61], s[60:61]
    v_rcp_f32 v48, v48
    v_rcp_f32 v49, v49
    v_rcp_f32 v50, v50
    v_rcp_f32 v51, v51
    v_pk_fma_f32 v[52:53], v[52:53], s[60:61], s[60:61]
    v_pk_fma_f32 v[54:55], v[54:55], s[60:61], s[60:61]
    v_rcp_f32 v52, v52
    v_rcp_f32 v53, v53
    v_rcp_f32 v54, v54
    v_rcp_f32 v55, v55
    v_pk_mul_f32 v[40:41], v[152:153], v[40:41]
    v_pk_mul_f32 v[42:43], v[154:155], v[42:43]
    v_pk_mul_f32 v[44:45], v[156:157], v[44:45]
    v_pk_mul_f32 v[46:47], v[158:159], v[46:47]
    v_pk_mul_f32 v[48:49], v[160:161], v[48:49]
    v_pk_mul_f32 v[50:51], v[162:163], v[50:51]
    v_pk_mul_f32 v[52:53], v[164:165], v[52:53]
    v_pk_mul_f32 v[54:55], v[166:167], v[54:55]
    v_cvt_pk_bf16_f32 v152, v40, v41
    v_cvt_pk_bf16_f32 v153, v42, v43
    v_cvt_pk_bf16_f32 v154, v44, v45
    v_cvt_pk_bf16_f32 v155, v46, v47
    v_cvt_pk_bf16_f32 v156, v48, v49
    v_cvt_pk_bf16_f32 v157, v50, v51
    v_cvt_pk_bf16_f32 v158, v52, v53
    v_cvt_pk_bf16_f32 v159, v54, v55
    buffer_store_dwordx4 v[152:155], v1, s[16:19], s51 offen sc1
    buffer_store_dwordx4 v[156:159], v1, s[16:19], s51 offen offset:1024 sc1
    s_add_u32 s51, s51, 73728
    s_branch L_P2
L_FFN3:
    s_lshl_b32 s36, s35, 13
    v_add_u32 v4, s36, v44
    v_xor_b32 v5, 64, v4
    v_add_u32 v32, 0x10000, v4
    v_add_u32 v33, 0x10000, v5
    s_and_b32 s63, s3, 2
    s_lshr_b32 s36, s63, 1
    s_lshl_b32 s67, s63, 6
    v_mul_u32_u24 v37, 3072, v3
    v_add_u32 v46, v46, v37
    v_xor_b32 v36, s63, v45
    v_xor_b32 v36, 0, v36
    v_lshl_add_u32 v6, v36, 5, v46
    v_add_u32 v34, 0x10000, v6
    v_xor_b32 v36, s63, v45
    v_xor_b32 v36, 1, v36
    v_lshl_add_u32 v7, v36, 5, v46
    v_add_u32 v35, 0x10000, v7
    v_lshlrev_b32 v36, 9, v3
    v_lshl_add_u32 v36, v47, 6, v36
    v_lshl_add_u32 v36, v48, 3, v36
    v_xor_b32 v37, s36, v49
    v_lshl_add_u32 v36, v37, 5, v36
    v_add_u32 v8, 147456, v36
    s_lshl_b32 s62, s63, 5
    s_sub_u32 s62, 768, s62
    v_lshlrev_b32 v38, 4, v3
    v_lshl_add_u32 v39, v2, 6, v38
    v_add_u32 v39, 512, v39
    v_add_u32 v38, s62, v38
    v_cmp_eq_u32 vcc, 2, v2
    s_nop 1
    v_cndmask_b32 v38, v39, v38, vcc
    s_lshl_b32 s36, s28, 4
    s_add_u32 s36, s36, s26
    s_lshl_b32 s36, s36, 10
    s_add_u32 s41, s36, s67
    s_add_u32 s41, s41, 10616832
    s_mov_b32 s44, 458759
    s_mov_b32 s45, 458759
    v_mov_b32 v28, s40
    v_mov_b32 v29, s40
    v_mov_b32 v30, s40
    v_mov_b32 v31, s40
    s_lshl_b32 s43, s26, 1
    s_add_u32 s43, s43, s35
    s_mul_i32 s43, s43, 294912
    v_and_b32 v10, 1, v3
    v_lshrrev_b32 v11, 1, v3
    v_lshlrev_b32 v39, 4, v2
    v_lshl_add_u32 v39, v11, 8, v39
    v_mul_u32_u24 v10, 73728, v10
    v_add_u32 v10, v10, v39
    s_mul_i32 s51, s37, 7
    s_add_u32 s51, s51, 16
    s_cmp_eq_u32 s39, 0
    s_cselect_b32 s52, 6, 0
    s_add_u32 s52, s52, s51
    s_add_u32 s51, s51, s39
    s_lshr_b32 s36, s63, 1
    s_add_u32 s51, s51, s36
    s_add_u32 s51, s51, 4
    s_lshl_b32 s52, s52, 10
    s_add_u32 s52, s52, s43
    s_lshl_b32 s36, s36, 9
    s_add_u32 s52, s52, s36
    s_lshl_b32 s51, s51, 10
    s_add_u32 s51, s51, s43
    s_mov_b32 s30, s35
    v_mov_b32 v36, 163328
    s_waitcnt vmcnt(0)
    s_barrier
    ds_read_b64_tr_b16 v[56:57], v6 offset:63488
    ds_read_b64_tr_b16 v[58:59], v6 offset:64000
    ds_read_b128 v[40:43], v4 offset:43008
    ds_read_b128 v[44:47], v4 offset:45056
    ds_read_b128 v[48:51], v4 offset:47104
    ds_read_b128 v[52:55], v4 offset:49152
    ds_read_b64_tr_b16 v[60:61], v7 offset:63488
    ds_read_b64_tr_b16 v[62:63], v7 offset:64000
    ds_read_b64_tr_b16 v[64:65], v8 offset:0
    ds_read_b64_tr_b16 v[66:67], v8 offset:256
    s_waitcnt lgkmcnt(0)
    s_cmp_lg_u32 s35, 0
    s_cbranch_scc1 FFN3_NOCS1
    v_mfma_f32_16x16x32_bf16 v[12:15], v[56:59], v[28:31], 0
    v_mfma_f32_16x16x32_bf16 v[16:19], v[60:63], v[28:31], 0
    v_mfma_f32_16x16x32_bf16 v[20:23], v[64:67], v[28:31], 0
FFN3_NOCS1:
    v_mfma_f32_16x16x32_bf16 v[104:107], v[56:59], v[40:43], 0
    ds_read_b64_tr_b16 v[88:89], v34 offset:10240
    v_mfma_f32_16x16x32_bf16 v[116:119], v[56:59], v[44:47], 0
    ds_read_b64_tr_b16 v[90:91], v34 offset:10752
    v_mfma_f32_16x16x32_bf16 v[128:131], v[56:59], v[48:51], 0
    ds_read_b128 v[72:75], v5 offset:43008
    s_cmp_lg_u32 s35, 0
    s_cbranch_scc1 FFN3_NOCS2
    v_cmp_eq_u32 vcc, 1, v2
    s_nop 1
    v_cndmask_b32 v12, v12, v16, vcc
    v_cndmask_b32 v13, v13, v17, vcc
    v_cndmask_b32 v14, v14, v18, vcc
    v_cndmask_b32 v15, v15, v19, vcc
    v_cmp_eq_u32 vcc, 2, v2
    s_nop 1
    v_cndmask_b32 v12, v12, v20, vcc
    v_cndmask_b32 v13, v13, v21, vcc
    v_cndmask_b32 v14, v14, v22, vcc
    v_cndmask_b32 v15, v15, v23, vcc
    s_mov_b64 exec, s[44:45]
    buffer_store_dwordx4 v[12:15], v38, s[16:19], s41 offen sc1
    s_mov_b64 exec, -1
FFN3_NOCS2:
    v_mfma_f32_16x16x32_bf16 v[140:143], v[56:59], v[52:55], 0
    ds_read_b128 v[76:79], v5 offset:45056
    v_mfma_f32_16x16x32_bf16 v[108:111], v[60:63], v[40:43], 0
    ds_read_b128 v[80:83], v5 offset:47104
    v_mfma_f32_16x16x32_bf16 v[120:123], v[60:63], v[44:47], 0
    ds_read_b128 v[84:87], v5 offset:49152
    v_mfma_f32_16x16x32_bf16 v[132:135], v[60:63], v[48:51], 0
    ds_read_b64_tr_b16 v[92:93], v35 offset:10240
    v_mfma_f32_16x16x32_bf16 v[144:147], v[60:63], v[52:55], 0
    ds_read_b64_tr_b16 v[94:95], v35 offset:10752
    v_mfma_f32_16x16x32_bf16 v[112:115], v[64:67], v[40:43], 0
    ds_read_b64_tr_b16 v[96:97], v8 offset:2048
    v_mfma_f32_16x16x32_bf16 v[124:127], v[64:67], v[44:47], 0
    ds_read_b64_tr_b16 v[98:99], v8 offset:2304
    v_mfma_f32_16x16x32_bf16 v[136:139], v[64:67], v[48:51], 0
    v_mfma_f32_16x16x32_bf16 v[148:151], v[64:67], v[52:55], 0
    s_waitcnt lgkmcnt(7)
    v_mfma_f32_16x16x32_bf16 v[104:107], v[88:91], v[72:75], v[104:107]
    s_waitcnt lgkmcnt(6)
    v_mfma_f32_16x16x32_bf16 v[116:119], v[88:91], v[76:79], v[116:119]
    s_waitcnt lgkmcnt(5)
    v_mfma_f32_16x16x32_bf16 v[128:131], v[88:91], v[80:83], v[128:131]
    s_waitcnt vmcnt(0) lgkmcnt(0)
    s_barrier
    ds_read_b64_tr_b16 v[56:57], v34 offset:40960
    ds_read_b64_tr_b16 v[58:59], v34 offset:41472
    v_mfma_f32_16x16x32_bf16 v[140:143], v[88:91], v[84:87], v[140:143]
    ds_read_b128 v[40:43], v32 offset:20480
    v_mfma_f32_16x16x32_bf16 v[108:111], v[92:95], v[72:75], v[108:111]
    ds_read_b128 v[44:47], v32 offset:22528
    v_mfma_f32_16x16x32_bf16 v[120:123], v[92:95], v[76:79], v[120:123]
    ds_read_b128 v[48:51], v32 offset:24576
    v_mfma_f32_16x16x32_bf16 v[132:135], v[92:95], v[80:83], v[132:135]
    ds_read_b128 v[52:55], v32 offset:26624
    v_mfma_f32_16x16x32_bf16 v[144:147], v[92:95], v[84:87], v[144:147]
    ds_read_b64_tr_b16 v[60:61], v35 offset:40960
    v_mfma_f32_16x16x32_bf16 v[112:115], v[96:99], v[72:75], v[112:115]
    ds_read_b64_tr_b16 v[62:63], v35 offset:41472
    v_mfma_f32_16x16x32_bf16 v[124:127], v[96:99], v[76:79], v[124:127]
    ds_read_b64_tr_b16 v[64:65], v8 offset:4096
    v_mfma_f32_16x16x32_bf16 v[136:139], v[96:99], v[80:83], v[136:139]
    ds_read_b64_tr_b16 v[66:67], v8 offset:4352
    v_mfma_f32_16x16x32_bf16 v[148:151], v[96:99], v[84:87], v[148:151]
    s_waitcnt lgkmcnt(7)
    v_mfma_f32_16x16x32_bf16 v[104:107], v[56:59], v[40:43], v[104:107]
    ds_read_b64_tr_b16 v[88:89], v34 offset:53248
    s_waitcnt lgkmcnt(7)
    v_mfma_f32_16x16x32_bf16 v[116:119], v[56:59], v[44:47], v[116:119]
    ds_read_b64_tr_b16 v[90:91], v34 offset:53760
    s_waitcnt lgkmcnt(7)
    v_mfma_f32_16x16x32_bf16 v[128:131], v[56:59], v[48:51], v[128:131]
    ds_read_b128 v[72:75], v33 offset:20480
    s_waitcnt lgkmcnt(7)
    v_mfma_f32_16x16x32_bf16 v[140:143], v[56:59], v[52:55], v[140:143]
    ds_read_b128 v[76:79], v33 offset:22528
    s_waitcnt lgkmcnt(6)
    v_mfma_f32_16x16x32_bf16 v[108:111], v[60:63], v[40:43], v[108:111]
    ds_read_b128 v[80:83], v33 offset:24576
    v_mfma_f32_16x16x32_bf16 v[120:123], v[60:63], v[44:47], v[120:123]
    ds_read_b128 v[84:87], v33 offset:26624
    v_mfma_f32_16x16x32_bf16 v[132:135], v[60:63], v[48:51], v[132:135]
    ds_read_b64_tr_b16 v[92:93], v35 offset:53248
    v_mfma_f32_16x16x32_bf16 v[144:147], v[60:63], v[52:55], v[144:147]
    ds_read_b64_tr_b16 v[94:95], v35 offset:53760
    s_waitcnt lgkmcnt(8)
    v_mfma_f32_16x16x32_bf16 v[112:115], v[64:67], v[40:43], v[112:115]
    ds_read_b64_tr_b16 v[96:97], v8 offset:6144
    v_mfma_f32_16x16x32_bf16 v[124:127], v[64:67], v[44:47], v[124:127]
    ds_read_b64_tr_b16 v[98:99], v8 offset:6400
    v_mfma_f32_16x16x32_bf16 v[136:139], v[64:67], v[48:51], v[136:139]
    v_mfma_f32_16x16x32_bf16 v[148:151], v[64:67], v[52:55], v[148:151]
    s_waitcnt lgkmcnt(7)
    v_mfma_f32_16x16x32_bf16 v[104:107], v[88:91], v[72:75], v[104:107]
    s_waitcnt lgkmcnt(6)
    v_mfma_f32_16x16x32_bf16 v[116:119], v[88:91], v[76:79], v[116:119]
    s_waitcnt lgkmcnt(5)
    v_mfma_f32_16x16x32_bf16 v[128:131], v[88:91], v[80:83], v[128:131]
    s_waitcnt lgkmcnt(0)
    s_barrier
    ds_read_b64_tr_b16 v[56:57], v6 offset:20480
    ds_read_b64_tr_b16 v[58:59], v6 offset:20992
    v_mfma_f32_16x16x32_bf16 v[140:143], v[88:91], v[84:87], v[140:143]
    ds_read_b128 v[40:43], v4 offset:0
    v_mfma_f32_16x16x32_bf16 v[108:111], v[92:95], v[72:75], v[108:111]
    ds_read_b128 v[44:47], v4 offset:2048
    v_mfma_f32_16x16x32_bf16 v[120:123], v[92:95], v[76:79], v[120:123]
    ds_read_b128 v[48:51], v4 offset:4096
    v_mfma_f32_16x16x32_bf16 v[132:135], v[92:95], v[80:83], v[132:135]
    ds_read_b128 v[52:55], v4 offset:6144
    v_mfma_f32_16x16x32_bf16 v[144:147], v[92:95], v[84:87], v[144:147]
    ds_read_b64_tr_b16 v[60:61], v7 offset:20480
    v_mfma_f32_16x16x32_bf16 v[112:115], v[96:99], v[72:75], v[112:115]
    ds_read_b64_tr_b16 v[62:63], v7 offset:20992
    v_mfma_f32_16x16x32_bf16 v[124:127], v[96:99], v[76:79], v[124:127]
    ds_read_b64_tr_b16 v[64:65], v8 offset:8192
    v_mfma_f32_16x16x32_bf16 v[136:139], v[96:99], v[80:83], v[136:139]
    ds_read_b64_tr_b16 v[66:67], v8 offset:8448
    v_mfma_f32_16x16x32_bf16 v[148:151], v[96:99], v[84:87], v[148:151]
    s_waitcnt lgkmcnt(7)
    v_mfma_f32_16x16x32_bf16 v[104:107], v[56:59], v[40:43], v[104:107]
    ds_read_b64_tr_b16 v[88:89], v6 offset:32768
    s_waitcnt lgkmcnt(7)
    v_mfma_f32_16x16x32_bf16 v[116:119], v[56:59], v[44:47], v[116:119]
    ds_read_b64_tr_b16 v[90:91], v6 offset:33280
    s_waitcnt lgkmcnt(7)
    v_mfma_f32_16x16x32_bf16 v[128:131], v[56:59], v[48:51], v[128:131]
    ds_read_b128 v[72:75], v5 offset:0
    s_waitcnt lgkmcnt(7)
    v_mfma_f32_16x16x32_bf16 v[140:143], v[56:59], v[52:55], v[140:143]
    ds_read_b128 v[76:79], v5 offset:2048
    s_waitcnt lgkmcnt(6)
    v_mfma_f32_16x16x32_bf16 v[108:111], v[60:63], v[40:43], v[108:111]
    ds_read_b128 v[80:83], v5 offset:4096
    v_mfma_f32_16x16x32_bf16 v[120:123], v[60:63], v[44:47], v[120:123]
    ds_read_b128 v[84:87], v5 offset:6144
    v_mfma_f32_16x16x32_bf16 v[132:135], v[60:63], v[48:51], v[132:135]
    ds_read_b64_tr_b16 v[92:93], v7 offset:32768
    v_mfma_f32_16x16x32_bf16 v[144:147], v[60:63], v[52:55], v[144:147]
    ds_read_b64_tr_b16 v[94:95], v7 offset:33280
    s_waitcnt lgkmcnt(8)
    v_mfma_f32_16x16x32_bf16 v[112:115], v[64:67], v[40:43], v[112:115]
    ds_read_b64_tr_b16 v[96:97], v8 offset:10240
    v_mfma_f32_16x16x32_bf16 v[124:127], v[64:67], v[44:47], v[124:127]
    ds_read_b64_tr_b16 v[98:99], v8 offset:10496
    v_mfma_f32_16x16x32_bf16 v[136:139], v[64:67], v[48:51], v[136:139]
    v_mfma_f32_16x16x32_bf16 v[148:151], v[64:67], v[52:55], v[148:151]
    s_waitcnt lgkmcnt(7)
    v_mfma_f32_16x16x32_bf16 v[104:107], v[88:91], v[72:75], v[104:107]
    s_waitcnt lgkmcnt(6)
    v_mfma_f32_16x16x32_bf16 v[116:119], v[88:91], v[76:79], v[116:119]
    s_waitcnt lgkmcnt(5)
    v_mfma_f32_16x16x32_bf16 v[128:131], v[88:91], v[80:83], v[128:131]
    s_waitcnt lgkmcnt(0)
    s_barrier
    ds_read_b64_tr_b16 v[56:57], v6 offset:63488
    ds_read_b64_tr_b16 v[58:59], v6 offset:64000
    v_mfma_f32_16x16x32_bf16 v[140:143], v[88:91], v[84:87], v[140:143]
    ds_read_b128 v[40:43], v4 offset:43008
    v_mfma_f32_16x16x32_bf16 v[108:111], v[92:95], v[72:75], v[108:111]
    ds_read_b128 v[44:47], v4 offset:45056
    v_mfma_f32_16x16x32_bf16 v[120:123], v[92:95], v[76:79], v[120:123]
    ds_read_b128 v[48:51], v4 offset:47104
    v_mfma_f32_16x16x32_bf16 v[132:135], v[92:95], v[80:83], v[132:135]
    ds_read_b128 v[52:55], v4 offset:49152
    v_mfma_f32_16x16x32_bf16 v[144:147], v[92:95], v[84:87], v[144:147]
    ds_read_b64_tr_b16 v[60:61], v7 offset:63488
    v_mfma_f32_16x16x32_bf16 v[112:115], v[96:99], v[72:75], v[112:115]
    ds_read_b64_tr_b16 v[62:63], v7 offset:64000
    v_mfma_f32_16x16x32_bf16 v[124:127], v[96:99], v[76:79], v[124:127]
    ds_read_b64_tr_b16 v[64:65], v8 offset:0
    v_mfma_f32_16x16x32_bf16 v[136:139], v[96:99], v[80:83], v[136:139]
    ds_read_b64_tr_b16 v[66:67], v8 offset:256
    v_mfma_f32_16x16x32_bf16 v[148:151], v[96:99], v[84:87], v[148:151]
    s_waitcnt lgkmcnt(7)
    v_mfma_f32_16x16x32_bf16 v[104:107], v[56:59], v[40:43], v[104:107]
    ds_read_b64_tr_b16 v[88:89], v34 offset:10240
    s_waitcnt lgkmcnt(7)
    v_mfma_f32_16x16x32_bf16 v[116:119], v[56:59], v[44:47], v[116:119]
    ds_read_b64_tr_b16 v[90:91], v34 offset:10752
    s_waitcnt lgkmcnt(7)
    v_mfma_f32_16x16x32_bf16 v[128:131], v[56:59], v[48:51], v[128:131]
    ds_read_b128 v[72:75], v5 offset:43008
    s_waitcnt lgkmcnt(7)
    v_mfma_f32_16x16x32_bf16 v[140:143], v[56:59], v[52:55], v[140:143]
    ds_read_b128 v[76:79], v5 offset:45056
    s_waitcnt lgkmcnt(6)
    v_mfma_f32_16x16x32_bf16 v[108:111], v[60:63], v[40:43], v[108:111]
    ds_read_b128 v[80:83], v5 offset:47104
    v_mfma_f32_16x16x32_bf16 v[120:123], v[60:63], v[44:47], v[120:123]
    ds_read_b128 v[84:87], v5 offset:49152
    v_mfma_f32_16x16x32_bf16 v[132:135], v[60:63], v[48:51], v[132:135]
    ds_read_b64_tr_b16 v[92:93], v35 offset:10240
    v_mfma_f32_16x16x32_bf16 v[144:147], v[60:63], v[52:55], v[144:147]
    ds_read_b64_tr_b16 v[94:95], v35 offset:10752
    s_waitcnt lgkmcnt(8)
    v_mfma_f32_16x16x32_bf16 v[112:115], v[64:67], v[40:43], v[112:115]
    ds_read_b64_tr_b16 v[96:97], v8 offset:2048
    v_mfma_f32_16x16x32_bf16 v[124:127], v[64:67], v[44:47], v[124:127]
    ds_read_b64_tr_b16 v[98:99], v8 offset:2304
    v_mfma_f32_16x16x32_bf16 v[136:139], v[64:67], v[48:51], v[136:139]
    v_mfma_f32_16x16x32_bf16 v[148:151], v[64:67], v[52:55], v[148:151]
    s_waitcnt lgkmcnt(7)
    v_mfma_f32_16x16x32_bf16 v[104:107], v[88:91], v[72:75], v[104:107]
    s_waitcnt lgkmcnt(6)
    v_mfma_f32_16x16x32_bf16 v[116:119], v[88:91], v[76:79], v[116:119]
    s_waitcnt lgkmcnt(5)
    v_mfma_f32_16x16x32_bf16 v[128:131], v[88:91], v[80:83], v[128:131]
    s_waitcnt lgkmcnt(0)
    s_barrier
    ds_read_b64_tr_b16 v[56:57], v34 offset:40960
    ds_read_b64_tr_b16 v[58:59], v34 offset:41472
    v_mfma_f32_16x16x32_bf16 v[140:143], v[88:91], v[84:87], v[140:143]
    ds_read_b128 v[40:43], v32 offset:20480
    v_mfma_f32_16x16x32_bf16 v[108:111], v[92:95], v[72:75], v[108:111]
    ds_read_b128 v[44:47], v32 offset:22528
    v_mfma_f32_16x16x32_bf16 v[120:123], v[92:95], v[76:79], v[120:123]
    ds_read_b128 v[48:51], v32 offset:24576
    v_mfma_f32_16x16x32_bf16 v[132:135], v[92:95], v[80:83], v[132:135]
    ds_read_b128 v[52:55], v32 offset:26624
    v_mfma_f32_16x16x32_bf16 v[144:147], v[92:95], v[84:87], v[144:147]
    ds_read_b64_tr_b16 v[60:61], v35 offset:40960
    v_mfma_f32_16x16x32_bf16 v[112:115], v[96:99], v[72:75], v[112:115]
    ds_read_b64_tr_b16 v[62:63], v35 offset:41472
    v_mfma_f32_16x16x32_bf16 v[124:127], v[96:99], v[76:79], v[124:127]
    ds_read_b64_tr_b16 v[64:65], v8 offset:4096
    v_mfma_f32_16x16x32_bf16 v[136:139], v[96:99], v[80:83], v[136:139]
    ds_read_b64_tr_b16 v[66:67], v8 offset:4352
    v_mfma_f32_16x16x32_bf16 v[148:151], v[96:99], v[84:87], v[148:151]
    s_waitcnt lgkmcnt(7)
    v_mfma_f32_16x16x32_bf16 v[104:107], v[56:59], v[40:43], v[104:107]
    ds_read_b64_tr_b16 v[88:89], v34 offset:53248
    s_waitcnt lgkmcnt(7)
    v_mfma_f32_16x16x32_bf16 v[116:119], v[56:59], v[44:47], v[116:119]
    ds_read_b64_tr_b16 v[90:91], v34 offset:53760
    s_waitcnt lgkmcnt(7)
    v_mfma_f32_16x16x32_bf16 v[128:131], v[56:59], v[48:51], v[128:131]
    ds_read_b128 v[72:75], v33 offset:20480
    s_waitcnt lgkmcnt(7)
    v_mfma_f32_16x16x32_bf16 v[140:143], v[56:59], v[52:55], v[140:143]
    ds_read_b128 v[76:79], v33 offset:22528
    s_waitcnt lgkmcnt(6)
    v_mfma_f32_16x16x32_bf16 v[108:111], v[60:63], v[40:43], v[108:111]
    ds_read_b128 v[80:83], v33 offset:24576
    v_mfma_f32_16x16x32_bf16 v[120:123], v[60:63], v[44:47], v[120:123]
    ds_read_b128 v[84:87], v33 offset:26624
    v_mfma_f32_16x16x32_bf16 v[132:135], v[60:63], v[48:51], v[132:135]
    ds_read_b64_tr_b16 v[92:93], v35 offset:53248
    v_mfma_f32_16x16x32_bf16 v[144:147], v[60:63], v[52:55], v[144:147]
    ds_read_b64_tr_b16 v[94:95], v35 offset:53760
    s_waitcnt lgkmcnt(8)
    v_mfma_f32_16x16x32_bf16 v[112:115], v[64:67], v[40:43], v[112:115]
    ds_read_b64_tr_b16 v[96:97], v8 offset:6144
    v_mfma_f32_16x16x32_bf16 v[124:127], v[64:67], v[44:47], v[124:127]
    ds_read_b64_tr_b16 v[98:99], v8 offset:6400
    v_mfma_f32_16x16x32_bf16 v[136:139], v[64:67], v[48:51], v[136:139]
    v_mfma_f32_16x16x32_bf16 v[148:151], v[64:67], v[52:55], v[148:151]
    s_waitcnt lgkmcnt(7)
    v_mfma_f32_16x16x32_bf16 v[104:107], v[88:91], v[72:75], v[104:107]
    s_waitcnt lgkmcnt(6)
    v_mfma_f32_16x16x32_bf16 v[116:119], v[88:91], v[76:79], v[116:119]
    s_waitcnt lgkmcnt(5)
    v_mfma_f32_16x16x32_bf16 v[128:131], v[88:91], v[80:83], v[128:131]
    s_waitcnt lgkmcnt(0)
    s_barrier
    ds_read_b64_tr_b16 v[56:57], v6 offset:20480
    ds_read_b64_tr_b16 v[58:59], v6 offset:20992
    v_mfma_f32_16x16x32_bf16 v[140:143], v[88:91], v[84:87], v[140:143]
    ds_read_b128 v[40:43], v4 offset:0
    v_mfma_f32_16x16x32_bf16 v[108:111], v[92:95], v[72:75], v[108:111]
    ds_read_b128 v[44:47], v4 offset:2048
    v_mfma_f32_16x16x32_bf16 v[120:123], v[92:95], v[76:79], v[120:123]
    ds_read_b128 v[48:51], v4 offset:4096
    v_mfma_f32_16x16x32_bf16 v[132:135], v[92:95], v[80:83], v[132:135]
    ds_read_b128 v[52:55], v4 offset:6144
    v_mfma_f32_16x16x32_bf16 v[144:147], v[92:95], v[84:87], v[144:147]
    ds_read_b64_tr_b16 v[60:61], v7 offset:20480
    v_mfma_f32_16x16x32_bf16 v[112:115], v[96:99], v[72:75], v[112:115]
    ds_read_b64_tr_b16 v[62:63], v7 offset:20992
    v_mfma_f32_16x16x32_bf16 v[124:127], v[96:99], v[76:79], v[124:127]
    ds_read_b64_tr_b16 v[64:65], v8 offset:8192
    v_mfma_f32_16x16x32_bf16 v[136:139], v[96:99], v[80:83], v[136:139]
    ds_read_b64_tr_b16 v[66:67], v8 offset:8448
    v_mfma_f32_16x16x32_bf16 v[148:151], v[96:99], v[84:87], v[148:151]
    s_waitcnt lgkmcnt(7)
    v_mfma_f32_16x16x32_bf16 v[104:107], v[56:59], v[40:43], v[104:107]
    ds_read_b64_tr_b16 v[88:89], v6 offset:32768
    s_waitcnt lgkmcnt(7)
    v_mfma_f32_16x16x32_bf16 v[116:119], v[56:59], v[44:47], v[116:119]
    ds_read_b64_tr_b16 v[90:91], v6 offset:33280
    s_waitcnt lgkmcnt(7)
    v_mfma_f32_16x16x32_bf16 v[128:131], v[56:59], v[48:51], v[128:131]
    ds_read_b128 v[72:75], v5 offset:0
    s_waitcnt lgkmcnt(7)
    v_mfma_f32_16x16x32_bf16 v[140:143], v[56:59], v[52:55], v[140:143]
    ds_read_b128 v[76:79], v5 offset:2048
    s_waitcnt lgkmcnt(6)
    v_mfma_f32_16x16x32_bf16 v[108:111], v[60:63], v[40:43], v[108:111]
    ds_read_b128 v[80:83], v5 offset:4096
    v_mfma_f32_16x16x32_bf16 v[120:123], v[60:63], v[44:47], v[120:123]
    ds_read_b128 v[84:87], v5 offset:6144
    v_mfma_f32_16x16x32_bf16 v[132:135], v[60:63], v[48:51], v[132:135]
    ds_read_b64_tr_b16 v[92:93], v7 offset:32768
    v_mfma_f32_16x16x32_bf16 v[144:147], v[60:63], v[52:55], v[144:147]
    ds_read_b64_tr_b16 v[94:95], v7 offset:33280
    s_waitcnt lgkmcnt(8)
    v_mfma_f32_16x16x32_bf16 v[112:115], v[64:67], v[40:43], v[112:115]
    ds_read_b64_tr_b16 v[96:97], v8 offset:10240
    v_mfma_f32_16x16x32_bf16 v[124:127], v[64:67], v[44:47], v[124:127]
    ds_read_b64_tr_b16 v[98:99], v8 offset:10496
    v_mfma_f32_16x16x32_bf16 v[136:139], v[64:67], v[48:51], v[136:139]
    v_mfma_f32_16x16x32_bf16 v[148:151], v[64:67], v[52:55], v[148:151]
    s_waitcnt lgkmcnt(7)
    v_mfma_f32_16x16x32_bf16 v[104:107], v[88:91], v[72:75], v[104:107]
    s_waitcnt lgkmcnt(6)
    v_mfma_f32_16x16x32_bf16 v[116:119], v[88:91], v[76:79], v[116:119]
    s_waitcnt lgkmcnt(5)
    v_mfma_f32_16x16x32_bf16 v[128:131], v[88:91], v[80:83], v[128:131]
    s_waitcnt lgkmcnt(0)
    s_barrier
    ds_read_b64_tr_b16 v[56:57], v6 offset:63488
    ds_read_b64_tr_b16 v[58:59], v6 offset:64000
    v_mfma_f32_16x16x32_bf16 v[140:143], v[88:91], v[84:87], v[140:143]
    ds_read_b128 v[40:43], v4 offset:43008
    v_mfma_f32_16x16x32_bf16 v[108:111], v[92:95], v[72:75], v[108:111]
    ds_read_b128 v[44:47], v4 offset:45056
    v_mfma_f32_16x16x32_bf16 v[120:123], v[92:95], v[76:79], v[120:123]
    ds_read_b128 v[48:51], v4 offset:47104
    v_mfma_f32_16x16x32_bf16 v[132:135], v[92:95], v[80:83], v[132:135]
    ds_read_b128 v[52:55], v4 offset:49152
    v_mfma_f32_16x16x32_bf16 v[144:147], v[92:95], v[84:87], v[144:147]
    ds_read_b64_tr_b16 v[60:61], v7 offset:63488
    v_mfma_f32_16x16x32_bf16 v[112:115], v[96:99], v[72:75], v[112:115]
    ds_read_b64_tr_b16 v[62:63], v7 offset:64000
    v_mfma_f32_16x16x32_bf16 v[124:127], v[96:99], v[76:79], v[124:127]
    ds_read_b64_tr_b16 v[64:65], v8 offset:0
    v_mfma_f32_16x16x32_bf16 v[136:139], v[96:99], v[80:83], v[136:139]
    ds_read_b64_tr_b16 v[66:67], v8 offset:256
    v_mfma_f32_16x16x32_bf16 v[148:151], v[96:99], v[84:87], v[148:151]
    s_waitcnt lgkmcnt(7)
    v_mfma_f32_16x16x32_bf16 v[104:107], v[56:59], v[40:43], v[104:107]
    ds_read_b64_tr_b16 v[88:89], v34 offset:10240
    ds_read_b64_tr_b16 v[90:91], v34 offset:10752
    s_waitcnt lgkmcnt(8)
    v_mfma_f32_16x16x32_bf16 v[116:119], v[56:59], v[44:47], v[116:119]
    ds_read_b128 v[72:75], v5 offset:43008
    s_waitcnt lgkmcnt(8)
    v_mfma_f32_16x16x32_bf16 v[128:131], v[56:59], v[48:51], v[128:131]
    ds_read_b128 v[76:79], v5 offset:45056
    s_waitcnt lgkmcnt(8)
    v_mfma_f32_16x16x32_bf16 v[140:143], v[56:59], v[52:55], v[140:143]
    ds_read_b128 v[80:83], v5 offset:47104
    s_waitcnt lgkmcnt(7)
    v_mfma_f32_16x16x32_bf16 v[108:111], v[60:63], v[40:43], v[108:111]
    ds_read_b128 v[84:87], v5 offset:49152
    v_mfma_f32_16x16x32_bf16 v[120:123], v[60:63], v[44:47], v[120:123]
    ds_read_b32 v37, v36 offset:192
    v_mfma_f32_16x16x32_bf16 v[132:135], v[60:63], v[48:51], v[132:135]
    ds_read_b64_tr_b16 v[92:93], v35 offset:10240
    v_mfma_f32_16x16x32_bf16 v[144:147], v[60:63], v[52:55], v[144:147]
    ds_read_b64_tr_b16 v[94:95], v35 offset:10752
    s_waitcnt lgkmcnt(9)
    v_mfma_f32_16x16x32_bf16 v[112:115], v[64:67], v[40:43], v[112:115]
    ds_read_b64_tr_b16 v[96:97], v8 offset:2048
    v_mfma_f32_16x16x32_bf16 v[124:127], v[64:67], v[44:47], v[124:127]
    ds_read_b64_tr_b16 v[98:99], v8 offset:2304
    v_mfma_f32_16x16x32_bf16 v[136:139], v[64:67], v[48:51], v[136:139]
    v_mov_b32 v38, 1
    s_mov_b64 exec, 1
    ds_add_u32 v36, v38 offset:120
    s_mov_b64 exec, -1
    v_mfma_f32_16x16x32_bf16 v[148:151], v[64:67], v[52:55], v[148:151]
    s_waitcnt lgkmcnt(5)
    v_readfirstlane_b32 s36, v37
    s_nop 0
    s_cmp_lt_u32 s36, 4
    s_cbranch_scc1 FFN3_LF7
FFN3_LF7_OK:
    v_mfma_f32_16x16x32_bf16 v[104:107], v[88:91], v[72:75], v[104:107]
    ds_read_b64_tr_b16 v[56:57], v34 offset:40960
    v_mfma_f32_16x16x32_bf16 v[116:119], v[88:91], v[76:79], v[116:119]
    ds_read_b64_tr_b16 v[58:59], v34 offset:41472
    v_mfma_f32_16x16x32_bf16 v[128:131], v[88:91], v[80:83], v[128:131]
    ds_read_b128 v[40:43], v32 offset:20480
    v_mfma_f32_16x16x32_bf16 v[140:143], v[88:91], v[84:87], v[140:143]
    ds_read_b128 v[44:47], v32 offset:22528
    s_waitcnt lgkmcnt(7)
    v_mfma_f32_16x16x32_bf16 v[108:111], v[92:95], v[72:75], v[108:111]
    ds_read_b128 v[48:51], v32 offset:24576
    v_mfma_f32_16x16x32_bf16 v[120:123], v[92:95], v[76:79], v[120:123]
    ds_read_b128 v[52:55], v32 offset:26624
    v_mfma_f32_16x16x32_bf16 v[132:135], v[92:95], v[80:83], v[132:135]
    ds_read_b64_tr_b16 v[60:61], v35 offset:40960
    v_mfma_f32_16x16x32_bf16 v[144:147], v[92:95], v[84:87], v[144:147]
    ds_read_b64_tr_b16 v[62:63], v35 offset:41472
    s_waitcnt lgkmcnt(9)
    v_mfma_f32_16x16x32_bf16 v[112:115], v[96:99], v[72:75], v[112:115]
    ds_read_b64_tr_b16 v[64:65], v8 offset:4096
    v_mfma_f32_16x16x32_bf16 v[124:127], v[96:99], v[76:79], v[124:127]
    ds_read_b64_tr_b16 v[66:67], v8 offset:4352
    v_mfma_f32_16x16x32_bf16 v[136:139], v[96:99], v[80:83], v[136:139]
    v_mfma_f32_16x16x32_bf16 v[148:151], v[96:99], v[84:87], v[148:151]
    s_waitcnt lgkmcnt(7)
    v_mfma_f32_16x16x32_bf16 v[104:107], v[56:59], v[40:43], v[104:107]
    ds_read_b64_tr_b16 v[88:89], v34 offset:53248
    s_waitcnt lgkmcnt(7)
    v_mfma_f32_16x16x32_bf16 v[116:119], v[56:59], v[44:47], v[116:119]
    ds_read_b64_tr_b16 v[90:91], v34 offset:53760
    s_waitcnt lgkmcnt(7)
    v_mfma_f32_16x16x32_bf16 v[128:131], v[56:59], v[48:51], v[128:131]
    ds_read_b128 v[72:75], v33 offset:20480
    s_waitcnt lgkmcnt(7)
    v_mfma_f32_16x16x32_bf16 v[140:143], v[56:59], v[52:55], v[140:143]
    ds_read_b128 v[76:79], v33 offset:22528
    s_waitcnt lgkmcnt(6)
    v_mfma_f32_16x16x32_bf16 v[108:111], v[60:63], v[40:43], v[108:111]
    ds_read_b128 v[80:83], v33 offset:24576
    v_mfma_f32_16x16x32_bf16 v[120:123], v[60:63], v[44:47], v[120:123]
    ds_read_b128 v[84:87], v33 offset:26624
    v_mfma_f32_16x16x32_bf16 v[132:135], v[60:63], v[48:51], v[132:135]
    ds_read_b64_tr_b16 v[92:93], v35 offset:53248
    v_mfma_f32_16x16x32_bf16 v[144:147], v[60:63], v[52:55], v[144:147]
    ds_read_b64_tr_b16 v[94:95], v35 offset:53760
    s_waitcnt lgkmcnt(8)
    v_mfma_f32_16x16x32_bf16 v[112:115], v[64:67], v[40:43], v[112:115]
    ds_read_b64_tr_b16 v[96:97], v8 offset:6144
    v_mfma_f32_16x16x32_bf16 v[124:127], v[64:67], v[44:47], v[124:127]
    ds_read_b64_tr_b16 v[98:99], v8 offset:6400
    v_mfma_f32_16x16x32_bf16 v[136:139], v[64:67], v[48:51], v[136:139]
    v_mov_b32 v38, 1
    s_mov_b64 exec, 1
    ds_add_u32 v36, v38 offset:124
    s_mov_b64 exec, -1
    v_mfma_f32_16x16x32_bf16 v[148:151], v[64:67], v[52:55], v[148:151]
    s_waitcnt lgkmcnt(8)
    v_mfma_f32_16x16x32_bf16 v[104:107], v[88:91], v[72:75], v[104:107]
    s_waitcnt lgkmcnt(7)
    v_mfma_f32_16x16x32_bf16 v[116:119], v[88:91], v[76:79], v[116:119]
    s_waitcnt lgkmcnt(6)
    v_mfma_f32_16x16x32_bf16 v[128:131], v[88:91], v[80:83], v[128:131]
    s_waitcnt lgkmcnt(5)
    v_mfma_f32_16x16x32_bf16 v[140:143], v[88:91], v[84:87], v[140:143]
    s_waitcnt lgkmcnt(3)
    v_mfma_f32_16x16x32_bf16 v[108:111], v[92:95], v[72:75], v[108:111]
    v_mfma_f32_16x16x32_bf16 v[120:123], v[92:95], v[76:79], v[120:123]
    v_mfma_f32_16x16x32_bf16 v[132:135], v[92:95], v[80:83], v[132:135]
    v_mfma_f32_16x16x32_bf16 v[144:147], v[92:95], v[84:87], v[144:147]
    s_waitcnt lgkmcnt(1)
    v_mfma_f32_16x16x32_bf16 v[112:115], v[96:99], v[72:75], v[112:115]
    v_mfma_f32_16x16x32_bf16 v[124:127], v[96:99], v[76:79], v[124:127]
    ds_read_b32 v37, v36 offset:8
    v_mfma_f32_16x16x32_bf16 v[136:139], v[96:99], v[80:83], v[136:139]
    v_mfma_f32_16x16x32_bf16 v[148:151], v[96:99], v[84:87], v[148:151]
    s_setprio 0
    s_waitcnt lgkmcnt(0)
    v_readfirstlane_b32 s36, v37
    s_nop 0
    s_cmp_lt_u32 s36, 4
    s_cbranch_scc1 FFN3_SSP
FFN3_SSP_OK:
    s_mov_b32 s60, 3216550459
    s_mov_b32 s61, 3216550459
    s_lshl_b32 s36, s35, 10
    s_add_u32 s36, s36, 159744
    v_lshl_add_u32 v36, v2, 4, s36
    s_add_u32 s42, s67, 162048
    v_lshl_add_u32 v37, v3, 4, s42
    ds_read_b128 v[72:75], v36
    ds_read_b128 v[12:15], v37 offset:512
    ds_read_b128 v[16:19], v37 offset:576
    v_add_u32 v38, s62, v37
    ds_read_b128 v[20:23], v38
    ds_read_b128 v[76:79], v36 offset:256
    ds_read_b128 v[80:83], v36 offset:512
    ds_read_b128 v[84:87], v36 offset:768
    s_waitcnt lgkmcnt(0)
    v_pk_mul_f32 v[74:75], s[60:61], v[74:75]
    v_pk_mul_f32 v[78:79], s[60:61], v[78:79]
    v_pk_mul_f32 v[82:83], s[60:61], v[82:83]
    v_pk_mul_f32 v[86:87], s[60:61], v[86:87]
    v_pk_fma_f32 v[104:105], v[12:13], v[72:73], v[104:105]
    v_pk_fma_f32 v[106:107], v[14:15], v[72:73], v[106:107]
    v_pk_mul_f32 v[104:105], v[104:105], v[74:75]
    v_pk_mul_f32 v[106:107], v[106:107], v[74:75]
    v_exp_f32 v40, v104
    v_exp_f32 v41, v105
    v_exp_f32 v42, v106
    v_exp_f32 v43, v107
    v_pk_fma_f32 v[108:109], v[16:17], v[72:73], v[108:109]
    v_pk_fma_f32 v[110:111], v[18:19], v[72:73], v[110:111]
    v_pk_mul_f32 v[108:109], v[108:109], v[74:75]
    v_pk_mul_f32 v[110:111], v[110:111], v[74:75]
    v_exp_f32 v44, v108
    v_exp_f32 v45, v109
    v_exp_f32 v46, v110
    v_exp_f32 v47, v111
    v_pk_fma_f32 v[112:113], v[20:21], v[72:73], v[112:113]
    v_pk_fma_f32 v[114:115], v[22:23], v[72:73], v[114:115]
    v_pk_mul_f32 v[112:113], v[112:113], v[74:75]
    v_pk_mul_f32 v[114:115], v[114:115], v[74:75]
    v_exp_f32 v48, v112
    v_exp_f32 v49, v113
    v_exp_f32 v50, v114
    v_exp_f32 v51, v115
    v_pk_fma_f32 v[40:41], v[40:41], s[60:61], s[60:61]
    v_pk_fma_f32 v[42:43], v[42:43], s[60:61], s[60:61]
    v_rcp_f32 v40, v40
    v_rcp_f32 v41, v41
    v_rcp_f32 v42, v42
    v_rcp_f32 v43, v43
    v_pk_fma_f32 v[44:45], v[44:45], s[60:61], s[60:61]
    v_pk_fma_f32 v[46:47], v[46:47], s[60:61], s[60:61]
    v_rcp_f32 v44, v44
    v_rcp_f32 v45, v45
    v_rcp_f32 v46, v46
    v_rcp_f32 v47, v47
    v_pk_fma_f32 v[48:49], v[48:49], s[60:61], s[60:61]
    v_pk_fma_f32 v[50:51], v[50:51], s[60:61], s[60:61]
    v_rcp_f32 v48, v48
    v_rcp_f32 v49, v49
    v_rcp_f32 v50, v50
    v_rcp_f32 v51, v51
    v_pk_mul_f32 v[40:41], v[104:105], v[40:41]
    v_pk_mul_f32 v[42:43], v[106:107], v[42:43]
    v_pk_mul_f32 v[44:45], v[108:109], v[44:45]
    v_pk_mul_f32 v[46:47], v[110:111], v[46:47]
    v_pk_mul_f32 v[48:49], v[112:113], v[48:49]
    v_pk_mul_f32 v[50:51], v[114:115], v[50:51]
    v_cvt_pk_bf16_f32 v104, v40, v41
    v_cvt_pk_bf16_f32 v105, v42, v43
    v_cvt_pk_bf16_f32 v106, v44, v45
    v_cvt_pk_bf16_f32 v107, v46, v47
    v_cvt_pk_bf16_f32 v56, v48, v49
    v_cvt_pk_bf16_f32 v57, v50, v51
    buffer_store_dwordx4 v[104:107], v1, s[16:19], s51 offen sc1
    s_add_u32 s51, s51, 73728
    v_pk_fma_f32 v[116:117], v[12:13], v[76:77], v[116:117]
    v_pk_fma_f32 v[118:119], v[14:15], v[76:77], v[118:119]
    v_pk_mul_f32 v[116:117], v[116:117], v[78:79]
    v_pk_mul_f32 v[118:119], v[118:119], v[78:79]
    v_exp_f32 v40, v116
    v_exp_f32 v41, v117
    v_exp_f32 v42, v118
    v_exp_f32 v43, v119
    v_pk_fma_f32 v[120:121], v[16:17], v[76:77], v[120:121]
    v_pk_fma_f32 v[122:123], v[18:19], v[76:77], v[122:123]
    v_pk_mul_f32 v[120:121], v[120:121], v[78:79]
    v_pk_mul_f32 v[122:123], v[122:123], v[78:79]
    v_exp_f32 v44, v120
    v_exp_f32 v45, v121
    v_exp_f32 v46, v122
    v_exp_f32 v47, v123
    v_pk_fma_f32 v[124:125], v[20:21], v[76:77], v[124:125]
    v_pk_fma_f32 v[126:127], v[22:23], v[76:77], v[126:127]
    v_pk_mul_f32 v[124:125], v[124:125], v[78:79]
    v_pk_mul_f32 v[126:127], v[126:127], v[78:79]
    v_exp_f32 v48, v124
    v_exp_f32 v49, v125
    v_exp_f32 v50, v126
    v_exp_f32 v51, v127
    v_pk_fma_f32 v[40:41], v[40:41], s[60:61], s[60:61]
    v_pk_fma_f32 v[42:43], v[42:43], s[60:61], s[60:61]
    v_rcp_f32 v40, v40
    v_rcp_f32 v41, v41
    v_rcp_f32 v42, v42
    v_rcp_f32 v43, v43
    v_pk_fma_f32 v[44:45], v[44:45], s[60:61], s[60:61]
    v_pk_fma_f32 v[46:47], v[46:47], s[60:61], s[60:61]
    v_rcp_f32 v44, v44
    v_rcp_f32 v45, v45
    v_rcp_f32 v46, v46
    v_rcp_f32 v47, v47
    v_pk_fma_f32 v[48:49], v[48:49], s[60:61], s[60:61]
    v_pk_fma_f32 v[50:51], v[50:51], s[60:61], s[60:61]
    v_rcp_f32 v48, v48
    v_rcp_f32 v49, v49
    v_rcp_f32 v50, v50
    v_rcp_f32 v51, v51
    v_pk_mul_f32 v[40:41], v[116:117], v[40:41]
    v_pk_mul_f32 v[42:43], v[118:119], v[42:43]
    v_pk_mul_f32 v[44:45], v[120:121], v[44:45]
    v_pk_mul_f32 v[46:47], v[122:123], v[46:47]
    v_pk_mul_f32 v[48:49], v[124:125], v[48:49]
    v_pk_mul_f32 v[50:51], v[126:127], v[50:51]
    v_cvt_pk_bf16_f32 v116, v40, v41
    v_cvt_pk_bf16_f32 v117, v42, v43
    v_cvt_pk_bf16_f32 v118, v44, v45
    v_cvt_pk_bf16_f32 v119, v46, v47
    v_cvt_pk_bf16_f32 v58, v48, v49
    v_cvt_pk_bf16_f32 v59, v50, v51
    buffer_store_dwordx4 v[116:119], v1, s[16:19], s51 offen sc1
    v_permlane16_swap_b32 v56, v58
    v_permlane16_swap_b32 v57, v59
    buffer_store_dwordx4 v[56:59], v10, s[16:19], s52 offen sc1
    s_add_u32 s52, s52, 147456
    s_add_u32 s51, s51, 73728
    v_pk_fma_f32 v[128:129], v[12:13], v[80:81], v[128:129]
    v_pk_fma_f32 v[130:131], v[14:15], v[80:81], v[130:131]
    v_pk_mul_f32 v[128:129], v[128:129], v[82:83]
    v_pk_mul_f32 v[130:131], v[130:131], v[82:83]
    v_exp_f32 v40, v128
    v_exp_f32 v41, v129
    v_exp_f32 v42, v130
    v_exp_f32 v43, v131
    v_pk_fma_f32 v[132:133], v[16:17], v[80:81], v[132:133]
    v_pk_fma_f32 v[134:135], v[18:19], v[80:81], v[134:135]
    v_pk_mul_f32 v[132:133], v[132:133], v[82:83]
    v_pk_mul_f32 v[134:135], v[134:135], v[82:83]
    v_exp_f32 v44, v132
    v_exp_f32 v45, v133
    v_exp_f32 v46, v134
    v_exp_f32 v47, v135
    v_pk_fma_f32 v[136:137], v[20:21], v[80:81], v[136:137]
    v_pk_fma_f32 v[138:139], v[22:23], v[80:81], v[138:139]
    v_pk_mul_f32 v[136:137], v[136:137], v[82:83]
    v_pk_mul_f32 v[138:139], v[138:139], v[82:83]
    v_exp_f32 v48, v136
    v_exp_f32 v49, v137
    v_exp_f32 v50, v138
    v_exp_f32 v51, v139
    v_pk_fma_f32 v[40:41], v[40:41], s[60:61], s[60:61]
    v_pk_fma_f32 v[42:43], v[42:43], s[60:61], s[60:61]
    v_rcp_f32 v40, v40
    v_rcp_f32 v41, v41
    v_rcp_f32 v42, v42
    v_rcp_f32 v43, v43
    v_pk_fma_f32 v[44:45], v[44:45], s[60:61], s[60:61]
    v_pk_fma_f32 v[46:47], v[46:47], s[60:61], s[60:61]
    v_rcp_f32 v44, v44
    v_rcp_f32 v45, v45
    v_rcp_f32 v46, v46
    v_rcp_f32 v47, v47
    v_pk_fma_f32 v[48:49], v[48:49], s[60:61], s[60:61]
    v_pk_fma_f32 v[50:51], v[50:51], s[60:61], s[60:61]
    v_rcp_f32 v48, v48
    v_rcp_f32 v49, v49
    v_rcp_f32 v50, v50
    v_rcp_f32 v51, v51
    v_pk_mul_f32 v[40:41], v[128:129], v[40:41]
    v_pk_mul_f32 v[42:43], v[130:131], v[42:43]
    v_pk_mul_f32 v[44:45], v[132:133], v[44:45]
    v_pk_mul_f32 v[46:47], v[134:135], v[46:47]
    v_pk_mul_f32 v[48:49], v[136:137], v[48:49]
    v_pk_mul_f32 v[50:51], v[138:139], v[50:51]
    v_cvt_pk_bf16_f32 v128, v40, v41
    v_cvt_pk_bf16_f32 v129, v42, v43
    v_cvt_pk_bf16_f32 v130, v44, v45
    v_cvt_pk_bf16_f32 v131, v46, v47
    v_cvt_pk_bf16_f32 v60, v48, v49
    v_cvt_pk_bf16_f32 v61, v50, v51
    buffer_store_dwordx4 v[128:131], v1, s[16:19], s51 offen sc1
    s_add_u32 s51, s51, 73728
    v_pk_fma_f32 v[140:141], v[12:13], v[84:85], v[140:141]
    v_pk_fma_f32 v[142:143], v[14:15], v[84:85], v[142:143]
    v_pk_mul_f32 v[140:141], v[140:141], v[86:87]
    v_pk_mul_f32 v[142:143], v[142:143], v[86:87]
    v_exp_f32 v40, v140
    v_exp_f32 v41, v141
    v_exp_f32 v42, v142
    v_exp_f32 v43, v143
    v_pk_fma_f32 v[144:145], v[16:17], v[84:85], v[144:145]
    v_pk_fma_f32 v[146:147], v[18:19], v[84:85], v[146:147]
    v_pk_mul_f32 v[144:145], v[144:145], v[86:87]
    v_pk_mul_f32 v[146:147], v[146:147], v[86:87]
    v_exp_f32 v44, v144
    v_exp_f32 v45, v145
    v_exp_f32 v46, v146
    v_exp_f32 v47, v147
    v_pk_fma_f32 v[148:149], v[20:21], v[84:85], v[148:149]
    v_pk_fma_f32 v[150:151], v[22:23], v[84:85], v[150:151]
    v_pk_mul_f32 v[148:149], v[148:149], v[86:87]
    v_pk_mul_f32 v[150:151], v[150:151], v[86:87]
    v_exp_f32 v48, v148
    v_exp_f32 v49, v149
    v_exp_f32 v50, v150
    v_exp_f32 v51, v151
    v_pk_fma_f32 v[40:41], v[40:41], s[60:61], s[60:61]
    v_pk_fma_f32 v[42:43], v[42:43], s[60:61], s[60:61]
    v_rcp_f32 v40, v40
    v_rcp_f32 v41, v41
    v_rcp_f32 v42, v42
    v_rcp_f32 v43, v43
    v_pk_fma_f32 v[44:45], v[44:45], s[60:61], s[60:61]
    v_pk_fma_f32 v[46:47], v[46:47], s[60:61], s[60:61]
    v_rcp_f32 v44, v44
    v_rcp_f32 v45, v45
    v_rcp_f32 v46, v46
    v_rcp_f32 v47, v47
    v_pk_fma_f32 v[48:49], v[48:49], s[60:61], s[60:61]
    v_pk_fma_f32 v[50:51], v[50:51], s[60:61], s[60:61]
    v_rcp_f32 v48, v48
    v_rcp_f32 v49, v49
    v_rcp_f32 v50, v50
    v_rcp_f32 v51, v51
    v_pk_mul_f32 v[40:41], v[140:141], v[40:41]
    v_pk_mul_f32 v[42:43], v[142:143], v[42:43]
    v_pk_mul_f32 v[44:45], v[144:145], v[44:45]
    v_pk_mul_f32 v[46:47], v[146:147], v[46:47]
    v_pk_mul_f32 v[48:49], v[148:149], v[48:49]
    v_pk_mul_f32 v[50:51], v[150:151], v[50:51]
    v_cvt_pk_bf16_f32 v140, v40, v41
    v_cvt_pk_bf16_f32 v141, v42, v43
    v_cvt_pk_bf16_f32 v142, v44, v45
    v_cvt_pk_bf16_f32 v143, v46, v47
    v_cvt_pk_bf16_f32 v62, v48, v49
    v_cvt_pk_bf16_f32 v63, v50, v51
    buffer_store_dwordx4 v[140:143], v1, s[16:19], s51 offen sc1
    v_permlane16_swap_b32 v60, v62
    v_permlane16_swap_b32 v61, v63
    buffer_store_dwordx4 v[60:63], v10, s[16:19], s52 offen sc1
    s_add_u32 s52, s52, 147456
    s_add_u32 s51, s51, 73728
L_P2:
    s_nop 1
    s_load_dword s45, s[16:17], s64 glc
    v_bfe_u32 v24, v0, 2, 3
    v_lshrrev_b32 v25, 1, v24
    v_lshrrev_b32 v26, 5, v0
    v_lshlrev_b32 v26, 10, v26
    v_lshl_add_u32 v26, v24, 7, v26
    v_and_b32 v27, 3, v0
    v_lshl_add_u32 v26, v27, 3, v26
    s_lshl_b32 s36, s32, 12
    v_add_u32 v26, s36, v26
    s_add_u32 s36, s32, 0
    s_and_b32 s36, s36, 3
    v_xor_b32 v27, s36, v25
    v_lshl_add_u32 v4, v27, 5, v26
    v_add_u32 v8, 0x10000, v4
    v_add_u32 v12, 0x20000, v4
    s_add_u32 s36, s32, 1
    s_and_b32 s36, s36, 3
    v_xor_b32 v27, s36, v25
    v_lshl_add_u32 v5, v27, 5, v26
    v_add_u32 v9, 0x10000, v5
    v_add_u32 v13, 0x20000, v5
    s_add_u32 s36, s32, 2
    s_and_b32 s36, s36, 3
    v_xor_b32 v27, s36, v25
    v_lshl_add_u32 v6, v27, 5, v26
    v_add_u32 v10, 0x10000, v6
    v_add_u32 v14, 0x20000, v6
    s_add_u32 s36, s32, 3
    s_and_b32 s36, s36, 3
    v_xor_b32 v27, s36, v25
    v_lshl_add_u32 v7, v27, 5, v26
    v_add_u32 v11, 0x10000, v7
    v_add_u32 v15, 0x20000, v7
    s_lshl_b32 s36, s48, 2
    s_lshl_b32 s42, s31, 1
    s_add_u32 s36, s36, s42
    s_mul_i32 s36, s36, 73728
    v_add_u32 v16, s36, v1
    v_add_u32 v17, 73728, v16
    s_lshr_b32 s41, s48, 1
    s_lshl_b32 s36, s41, 7
    s_lshl_b32 s42, s31, 6
    s_add_u32 s36, s36, s42
    s_and_b32 s43, s48, 1
    s_add_u32 s36, s36, s43
    s_lshl_b32 s36, s36, 10
    s_lshl_b32 s42, s49, 7
    s_add_u32 s36, s36, s42
    s_lshl_b32 s42, s32, 5
    s_add_u32 s36, s36, s42
    v_lshlrev_b32 v18, 11, v2
    v_lshl_add_u32 v18, v3, 3, v18
    v_add_u32 v18, s36, v18
    v_add_u32 v19, 0x8000, v18
    s_lshl_b32 s36, s31, 2
    v_mov_b32 v26, s36
    v_add_u32 v24, 163328, v26
    v_mov_b32 v25, 1
    s_lshl_b32 s57, s32, 3
    s_add_u32 s57, s57, s36
    s_add_u32 s57, s57, 163376
    v_mov_b32 v20, s57
    s_lshl_b32 s36, s32, 2
    s_add_u32 s36, s36, 163344
    v_mov_b32 v22, s36
    s_lshl_b32 s36, s31, 15
    s_lshl_b32 s42, s32, 12
    s_add_u32 s36, s36, s42
    v_lshlrev_b32 v27, 8, v2
    v_add_u32 v27, s36, v27
    s_add_u32 s36, s32, 0
    s_and_b32 s36, s36, 3
    s_lshl_b32 s36, s36, 2
    v_add_u32 v28, s36, v3
    v_xor_b32 v28, v28, v2
    v_lshl_add_u32 v148, v28, 4, v27
    s_add_u32 s36, s32, 1
    s_and_b32 s36, s36, 3
    s_lshl_b32 s36, s36, 2
    v_add_u32 v28, s36, v3
    v_xor_b32 v28, v28, v2
    v_lshl_add_u32 v149, v28, 4, v27
    s_add_u32 s36, s32, 2
    s_and_b32 s36, s36, 3
    s_lshl_b32 s36, s36, 2
    v_add_u32 v28, s36, v3
    v_xor_b32 v28, v28, v2
    v_lshl_add_u32 v150, v28, 4, v27
    s_add_u32 s36, s32, 3
    s_and_b32 s36, s36, 3
    s_lshl_b32 s36, s36, 2
    v_add_u32 v28, s36, v3
    v_xor_b32 v28, v28, v2
    v_lshl_add_u32 v151, v28, 4, v27
    v_lshrrev_b32 v27, 3, v0
    s_lshl_b32 s36, s35, 3
    v_add_u32 v27, s36, v27
    v_and_b32 v28, 7, v0
    v_lshlrev_b32 v29, 1, v28
    v_xor_b32 v29, v29, v27
    s_lshr_b32 s42, s3, 1
    s_lshl_b32 s36, s42, 14
    v_lshlrev_b32 v30, 8, v27
    v_add_u32 v30, s36, v30
    v_lshl_add_u32 v152, v29, 4, v30
    v_xor_b32 v153, 16, v152
    s_lshr_b32 s36, s48, 1
    s_lshl_b32 s36, s36, 7
    s_lshl_b32 s42, s42, 5
    s_add_u32 s36, s36, s42
    s_and_b32 s42, s48, 1
    s_add_u32 s36, s36, s42
    s_lshl_b32 s36, s36, 10
    s_lshl_b32 s42, s49, 7
    s_add_u32 s36, s36, s42
    v_lshlrev_b32 v18, 11, v27
    v_lshl_add_u32 v18, v28, 4, v18
    v_add_u32 v18, s36, v18
    s_lshl_b32 s41, s48, 3
    s_add_u32 s41, s41, s49
    s_lshl_b32 s41, s41, 2
    s_add_u32 s41, s41, s32
    s_lshl_b32 s41, s41, 7
    s_add_u32 s41, s41, 11010048
    s_and_b32 s36, s48, 1
    s_lshl_b32 s56, 0x50500000, s36
    s_lshl_b32 s62, 0x05050000, s36
    s_lshl_b32 s36, s36, 2
    s_lshl_b32 s42, 0x0f0f, s36
    s_and_b32 s36, s50, 4
    s_lshl_b32 s36, s36, 1
    s_lshl_b32 s43, 0xff0000, s36
    s_or_b32 s46, s42, s62
    s_and_b32 s43, s43, s62
    s_xor_b32 s62, s62, s43
    s_or_b32 s46, s46, s56
    v_lshlrev_b32 v164, 9, v0
    v_mov_b32 v165, v24
    s_lshr_b32 s36, s28, 3
    s_lshl_b32 s36, s36, 1
    s_and_b32 s61, s28, 1
    s_add_u32 s36, s36, s61
    s_lshl_b32 s36, s36, 3
    s_add_u32 s36, s36, s3
    s_lshl_b32 s47, 1, s36
    v_mov_b32 v163, s47
    s_lshl_b32 s36, s30, 12
    s_add_u32 s66, s66, s36
    s_mov_b32 s61, 0
    s_setprio 0
    v_mov_b32 v166, 1
    s_waitcnt vmcnt(0)
    s_mov_b32 s61, 1
    s_mov_b64 exec, 0xff
    buffer_atomic_or v163, v164, s[16:19], s66 offen sc1
    s_mov_b64 exec, 1
    ds_add_u32 v165, v166
    s_mov_b64 exec, -1
    v_lshlrev_b32 v0, 7, v2
    v_lshl_add_u32 v0, v3, 2, v0
    v_mov_b32 v2, 0
    s_waitcnt lgkmcnt(0)
    s_mov_b32 s59, 0
    ds_read_b32 v3, v22 offset:16
    s_waitcnt lgkmcnt(0)
    v_readfirstlane_b32 s36, v3
    s_nop 0
    s_or_b32 s45, s45, s36
    s_and_b32 s36, s45, s43
    s_cmp_lg_u32 s36, s43
    s_cbranch_scc1 P2_G0
P2_G0_OK:
    buffer_load_dwordx4 v[104:107], v16, s[16:19], s72 offen sc1
    buffer_load_dwordx4 v[108:111], v17, s[16:19], s72 offen sc1
    buffer_load_dwordx4 v[112:115], v16, s[16:19], s73 offen sc1
    buffer_load_dwordx4 v[116:119], v17, s[16:19], s73 offen sc1
    buffer_load_dwordx4 v[120:123], v16, s[16:19], s74 offen sc1
    buffer_load_dwordx4 v[124:127], v17, s[16:19], s74 offen sc1
    buffer_load_dwordx4 v[128:131], v16, s[16:19], s75 offen sc1
    buffer_load_dwordx4 v[132:135], v17, s[16:19], s75 offen sc1
    s_cmp_lt_u32 s59, 2
    s_cbranch_scc1 P2_FULL2
P2_FULL2_OK:
    ds_read_b64_tr_b16 v[56:57], v4 offset:0
    ds_read_b64_tr_b16 v[58:59], v4 offset:2048
    ds_read_b64_tr_b16 v[60:61], v5 offset:0
    ds_read_b64_tr_b16 v[62:63], v5 offset:2048
    ds_read_b64_tr_b16 v[64:65], v6 offset:0
    ds_read_b64_tr_b16 v[66:67], v6 offset:2048
    ds_read_b64_tr_b16 v[68:69], v7 offset:0
    ds_read_b64_tr_b16 v[70:71], v7 offset:2048
    v_mov_b32 v21, 1
    ds_write_b32 v20, v21
    ds_read_b64_tr_b16 v[72:73], v4 offset:16384
    ds_read_b64_tr_b16 v[74:75], v4 offset:18432
    ds_read_b64_tr_b16 v[76:77], v5 offset:16384
    ds_read_b64_tr_b16 v[78:79], v5 offset:18432
    ds_read_b64_tr_b16 v[80:81], v6 offset:16384
    ds_read_b64_tr_b16 v[82:83], v6 offset:18432
    ds_read_b64_tr_b16 v[84:85], v7 offset:16384
    ds_read_b64_tr_b16 v[86:87], v7 offset:18432
    v_mov_b32 v21, 2
    ds_write_b32 v20, v21
    s_setprio 3
    s_waitcnt vmcnt(6) lgkmcnt(10)
    v_mfma_f32_16x16x32_bf16 v[24:27], v[56:59], v[104:107], 0
    s_cmp_lt_u32 s59, 3
    s_cbranch_scc1 P2_FULL3
P2_FULL3_OK:
    ds_read_b32 v3, v22 offset:16
    v_mfma_f32_16x16x32_bf16 v[28:31], v[56:59], v[108:111], 0
    ds_read_b64_tr_b16 v[88:89], v4 offset:32768
    v_mfma_f32_16x16x32_bf16 v[32:35], v[60:63], v[104:107], 0
    ds_read_b64_tr_b16 v[90:91], v4 offset:34816
    ds_read_b64_tr_b16 v[92:93], v5 offset:32768
    v_mfma_f32_16x16x32_bf16 v[36:39], v[60:63], v[108:111], 0
    ds_read_b64_tr_b16 v[94:95], v5 offset:34816
    v_mfma_f32_16x16x32_bf16 v[40:43], v[64:67], v[104:107], 0
    ds_read_b64_tr_b16 v[96:97], v6 offset:32768
    v_mfma_f32_16x16x32_bf16 v[44:47], v[64:67], v[108:111], 0
    ds_read_b64_tr_b16 v[98:99], v6 offset:34816
    ds_read_b64_tr_b16 v[100:101], v7 offset:32768
    v_mfma_f32_16x16x32_bf16 v[48:51], v[68:71], v[104:107], 0
    ds_read_b64_tr_b16 v[102:103], v7 offset:34816
    v_mfma_f32_16x16x32_bf16 v[52:55], v[68:71], v[108:111], 0
    v_mov_b32 v21, 3
    ds_write_b32 v20, v21
    s_waitcnt vmcnt(4) lgkmcnt(11)
    v_mfma_f32_16x16x32_bf16 v[24:27], v[72:75], v[112:115], v[24:27]
    s_cmp_lt_u32 s59, 4
    s_cbranch_scc1 P2_FULL4
P2_FULL4_OK:
    s_waitcnt lgkmcnt(9)
    v_readfirstlane_b32 s36, v3
    s_nop 0
    s_or_b32 s45, s45, s36
    s_and_b32 s36, s45, s62
    s_cmp_lg_u32 s36, s62
    s_cbranch_scc1 P2_G4
P2_G4_OK:
    v_mfma_f32_16x16x32_bf16 v[28:31], v[72:75], v[116:119], v[28:31]
    ds_read_b32 v23, v22
    buffer_load_dwordx4 v[104:107], v16, s[16:19], s76 offen sc1
    v_mfma_f32_16x16x32_bf16 v[32:35], v[76:79], v[112:115], v[32:35]
    ds_read_b64_tr_b16 v[56:57], v4 offset:49152
    buffer_load_dwordx4 v[108:111], v17, s[16:19], s76 offen sc1
    v_mfma_f32_16x16x32_bf16 v[36:39], v[76:79], v[116:119], v[36:39]
    ds_read_b64_tr_b16 v[58:59], v4 offset:51200
    v_mfma_f32_16x16x32_bf16 v[40:43], v[80:83], v[112:115], v[40:43]
    ds_read_b64_tr_b16 v[60:61], v5 offset:49152
    ds_read_b64_tr_b16 v[62:63], v5 offset:51200
    v_mfma_f32_16x16x32_bf16 v[44:47], v[80:83], v[116:119], v[44:47]
    ds_read_b64_tr_b16 v[64:65], v6 offset:49152
    ds_read_b64_tr_b16 v[66:67], v6 offset:51200
    v_mfma_f32_16x16x32_bf16 v[48:51], v[84:87], v[112:115], v[48:51]
    ds_read_b64_tr_b16 v[68:69], v7 offset:49152
    ds_read_b64_tr_b16 v[70:71], v7 offset:51200
    v_mfma_f32_16x16x32_bf16 v[52:55], v[84:87], v[116:119], v[52:55]
    v_mov_b32 v21, 4
    ds_write_b32 v20, v21
    s_waitcnt vmcnt(4) lgkmcnt(9)
    v_mfma_f32_16x16x32_bf16 v[24:27], v[88:91], v[120:123], v[24:27]
    v_readfirstlane_b32 s59, v23
    s_nop 0
    s_cmp_lt_u32 s59, 5
    s_cbranch_scc1 P2_FULL5
P2_FULL5_OK:
    v_mfma_f32_16x16x32_bf16 v[28:31], v[88:91], v[124:127], v[28:31]
    buffer_load_dwordx4 v[112:115], v16, s[16:19], s77 offen sc1
    ds_read_b64_tr_b16 v[72:73], v8 offset:0
    v_mfma_f32_16x16x32_bf16 v[32:35], v[92:95], v[120:123], v[32:35]
    buffer_load_dwordx4 v[116:119], v17, s[16:19], s77 offen sc1
    v_mfma_f32_16x16x32_bf16 v[36:39], v[92:95], v[124:127], v[36:39]
    ds_read_b64_tr_b16 v[74:75], v8 offset:2048
    ds_read_b64_tr_b16 v[76:77], v9 offset:0
    v_mfma_f32_16x16x32_bf16 v[40:43], v[96:99], v[120:123], v[40:43]
    ds_read_b64_tr_b16 v[78:79], v9 offset:2048
    ds_read_b64_tr_b16 v[80:81], v10 offset:0
    v_mfma_f32_16x16x32_bf16 v[44:47], v[96:99], v[124:127], v[44:47]
    ds_read_b64_tr_b16 v[82:83], v10 offset:2048
    v_mfma_f32_16x16x32_bf16 v[48:51], v[100:103], v[120:123], v[48:51]
    ds_read_b64_tr_b16 v[84:85], v11 offset:0
    ds_read_b64_tr_b16 v[86:87], v11 offset:2048
    v_mfma_f32_16x16x32_bf16 v[52:55], v[100:103], v[124:127], v[52:55]
    v_mov_b32 v21, 5
    ds_write_b32 v20, v21
    s_waitcnt vmcnt(4) lgkmcnt(10)
    v_mfma_f32_16x16x32_bf16 v[24:27], v[56:59], v[128:131], v[24:27]
    s_cmp_lt_u32 s59, 6
    s_cbranch_scc1 P2_FULL6
P2_FULL6_OK:
    buffer_load_dwordx4 v[120:123], v16, s[16:19], s78 offen sc1
    v_mfma_f32_16x16x32_bf16 v[28:31], v[56:59], v[132:135], v[28:31]
    ds_read_b32 v23, v22
    buffer_load_dwordx4 v[124:127], v17, s[16:19], s78 offen sc1
    v_mfma_f32_16x16x32_bf16 v[32:35], v[60:63], v[128:131], v[32:35]
    ds_read_b64_tr_b16 v[88:89], v8 offset:16384
    v_mfma_f32_16x16x32_bf16 v[36:39], v[60:63], v[132:135], v[36:39]
    ds_read_b64_tr_b16 v[90:91], v8 offset:18432
    ds_read_b64_tr_b16 v[92:93], v9 offset:16384
    v_mfma_f32_16x16x32_bf16 v[40:43], v[64:67], v[128:131], v[40:43]
    ds_read_b64_tr_b16 v[94:95], v9 offset:18432
    ds_read_b64_tr_b16 v[96:97], v10 offset:16384
    v_mfma_f32_16x16x32_bf16 v[44:47], v[64:67], v[132:135], v[44:47]
    ds_read_b64_tr_b16 v[98:99], v10 offset:18432
    v_mfma_f32_16x16x32_bf16 v[48:51], v[68:71], v[128:131], v[48:51]
    ds_read_b64_tr_b16 v[100:101], v11 offset:16384
    ds_read_b64_tr_b16 v[102:103], v11 offset:18432
    v_mfma_f32_16x16x32_bf16 v[52:55], v[68:71], v[132:135], v[52:55]
    v_mov_b32 v21, 6
    ds_write_b32 v20, v21
    s_setprio 2
    s_waitcnt vmcnt(4) lgkmcnt(9)
    v_mfma_f32_16x16x32_bf16 v[24:27], v[72:75], v[104:107], v[24:27]
    v_readfirstlane_b32 s59, v23
    s_nop 0
    s_cmp_lt_u32 s59, 7
    s_cbranch_scc1 P2_FULL7
P2_FULL7_OK:
    v_mfma_f32_16x16x32_bf16 v[28:31], v[72:75], v[108:111], v[28:31]
    buffer_load_dwordx4 v[128:131], v16, s[16:19], s79 offen sc1
    ds_read_b32 v3, v22 offset:16
    v_mfma_f32_16x16x32_bf16 v[32:35], v[76:79], v[104:107], v[32:35]
    buffer_load_dwordx4 v[132:135], v17, s[16:19], s79 offen sc1
    ds_read_b64_tr_b16 v[56:57], v8 offset:32768
    v_mfma_f32_16x16x32_bf16 v[36:39], v[76:79], v[108:111], v[36:39]
    ds_read_b64_tr_b16 v[58:59], v8 offset:34816
    v_mfma_f32_16x16x32_bf16 v[40:43], v[80:83], v[104:107], v[40:43]
    ds_read_b64_tr_b16 v[60:61], v9 offset:32768
    ds_read_b64_tr_b16 v[62:63], v9 offset:34816
    v_mfma_f32_16x16x32_bf16 v[44:47], v[80:83], v[108:111], v[44:47]
    ds_read_b64_tr_b16 v[64:65], v10 offset:32768
    ds_read_b64_tr_b16 v[66:67], v10 offset:34816
    v_mfma_f32_16x16x32_bf16 v[48:51], v[84:87], v[104:107], v[48:51]
    ds_read_b64_tr_b16 v[68:69], v11 offset:32768
    ds_read_b64_tr_b16 v[70:71], v11 offset:34816
    v_mfma_f32_16x16x32_bf16 v[52:55], v[84:87], v[108:111], v[52:55]
    v_mov_b32 v21, 7
    ds_write_b32 v20, v21
    s_waitcnt vmcnt(4) lgkmcnt(11)
    v_mfma_f32_16x16x32_bf16 v[24:27], v[88:91], v[112:115], v[24:27]
    s_cmp_lt_u32 s59, 8
    s_cbranch_scc1 P2_FULL8
P2_FULL8_OK:
    s_waitcnt lgkmcnt(9)
    v_readfirstlane_b32 s36, v3
    s_nop 0
    s_or_b32 s45, s45, s36
    s_and_b32 s36, s45, s42
    s_cmp_lg_u32 s36, s42
    s_cbranch_scc1 P2_G8
P2_G8_OK:
    v_mfma_f32_16x16x32_bf16 v[28:31], v[88:91], v[116:119], v[28:31]
    ds_read_b32 v23, v22
    buffer_load_dwordx4 v[104:107], v16, s[16:19], s96 offen sc1
    v_mfma_f32_16x16x32_bf16 v[32:35], v[92:95], v[112:115], v[32:35]
    ds_read_b64_tr_b16 v[72:73], v8 offset:49152
    buffer_load_dwordx4 v[108:111], v17, s[16:19], s96 offen sc1
    v_mfma_f32_16x16x32_bf16 v[36:39], v[92:95], v[116:119], v[36:39]
    ds_read_b64_tr_b16 v[74:75], v8 offset:51200
    v_mfma_f32_16x16x32_bf16 v[40:43], v[96:99], v[112:115], v[40:43]
    ds_read_b64_tr_b16 v[76:77], v9 offset:49152
    ds_read_b64_tr_b16 v[78:79], v9 offset:51200
    v_mfma_f32_16x16x32_bf16 v[44:47], v[96:99], v[116:119], v[44:47]
    ds_read_b64_tr_b16 v[80:81], v10 offset:49152
    ds_read_b64_tr_b16 v[82:83], v10 offset:51200
    v_mfma_f32_16x16x32_bf16 v[48:51], v[100:103], v[112:115], v[48:51]
    ds_read_b64_tr_b16 v[84:85], v11 offset:49152
    ds_read_b64_tr_b16 v[86:87], v11 offset:51200
    v_mfma_f32_16x16x32_bf16 v[52:55], v[100:103], v[116:119], v[52:55]
    v_mov_b32 v21, 8
    ds_write_b32 v20, v21
    s_waitcnt vmcnt(4) lgkmcnt(9)
    v_mfma_f32_16x16x32_bf16 v[24:27], v[56:59], v[120:123], v[24:27]
    v_readfirstlane_b32 s59, v23
    s_nop 0
    s_cmp_lt_u32 s59, 9
    s_cbranch_scc1 P2_FULL9
P2_FULL9_OK:
    v_mfma_f32_16x16x32_bf16 v[28:31], v[56:59], v[124:127], v[28:31]
    buffer_load_dwordx4 v[112:115], v16, s[16:19], s97 offen sc1
    ds_read_b64_tr_b16 v[88:89], v12 offset:0
    v_mfma_f32_16x16x32_bf16 v[32:35], v[60:63], v[120:123], v[32:35]
    buffer_load_dwordx4 v[116:119], v17, s[16:19], s97 offen sc1
    v_mfma_f32_16x16x32_bf16 v[36:39], v[60:63], v[124:127], v[36:39]
    ds_read_b64_tr_b16 v[90:91], v12 offset:2048
    ds_read_b64_tr_b16 v[92:93], v13 offset:0
    v_mfma_f32_16x16x32_bf16 v[40:43], v[64:67], v[120:123], v[40:43]
    ds_read_b64_tr_b16 v[94:95], v13 offset:2048
    ds_read_b64_tr_b16 v[96:97], v14 offset:0
    v_mfma_f32_16x16x32_bf16 v[44:47], v[64:67], v[124:127], v[44:47]
    ds_read_b64_tr_b16 v[98:99], v14 offset:2048
    v_mfma_f32_16x16x32_bf16 v[48:51], v[68:71], v[120:123], v[48:51]
    ds_read_b64_tr_b16 v[100:101], v15 offset:0
    ds_read_b64_tr_b16 v[102:103], v15 offset:2048
    v_mfma_f32_16x16x32_bf16 v[52:55], v[68:71], v[124:127], v[52:55]
    v_mov_b32 v21, 9
    ds_write_b32 v20, v21
    s_waitcnt vmcnt(4) lgkmcnt(10)
    v_mfma_f32_16x16x32_bf16 v[24:27], v[72:75], v[128:131], v[24:27]
    s_cmp_lt_u32 s59, 10
    s_cbranch_scc1 P2_FULL10
P2_FULL10_OK:
    buffer_load_dwordx4 v[120:123], v16, s[16:19], s98 offen sc1
    v_mfma_f32_16x16x32_bf16 v[28:31], v[72:75], v[132:135], v[28:31]
    ds_read_b32 v23, v22
    v_mfma_f32_16x16x32_bf16 v[32:35], v[76:79], v[128:131], v[32:35]
    buffer_load_dwordx4 v[124:127], v17, s[16:19], s98 offen sc1
    ds_read_b64_tr_b16 v[56:57], v4 offset:0
    v_mfma_f32_16x16x32_bf16 v[36:39], v[76:79], v[132:135], v[36:39]
    ds_read_b64_tr_b16 v[58:59], v4 offset:2048
    v_mfma_f32_16x16x32_bf16 v[40:43], v[80:83], v[128:131], v[40:43]
    ds_read_b64_tr_b16 v[60:61], v5 offset:0
    ds_read_b64_tr_b16 v[62:63], v5 offset:2048
    v_mfma_f32_16x16x32_bf16 v[44:47], v[80:83], v[132:135], v[44:47]
    ds_read_b64_tr_b16 v[64:65], v6 offset:0
    v_mfma_f32_16x16x32_bf16 v[48:51], v[84:87], v[128:131], v[48:51]
    ds_read_b64_tr_b16 v[66:67], v6 offset:2048
    ds_read_b64_tr_b16 v[68:69], v7 offset:0
    v_mfma_f32_16x16x32_bf16 v[52:55], v[84:87], v[132:135], v[52:55]
    ds_read_b64_tr_b16 v[70:71], v7 offset:2048
    s_setprio 1
    s_waitcnt vmcnt(4) lgkmcnt(8)
    v_mfma_f32_16x16x32_bf16 v[24:27], v[88:91], v[104:107], v[24:27]
    v_readfirstlane_b32 s59, v23
    s_nop 0
    s_cmp_lt_u32 s59, 11
    s_cbranch_scc1 P2_FULL11
P2_FULL11_OK:
    v_mfma_f32_16x16x32_bf16 v[28:31], v[88:91], v[108:111], v[28:31]
    buffer_load_dwordx4 v[128:131], v16, s[16:19], s99 offen sc1
    ds_read_b32 v3, v22 offset:16
    v_mfma_f32_16x16x32_bf16 v[32:35], v[92:95], v[104:107], v[32:35]
    buffer_load_dwordx4 v[132:135], v17, s[16:19], s99 offen sc1
    v_mfma_f32_16x16x32_bf16 v[36:39], v[92:95], v[108:111], v[36:39]
    ds_read_b64_tr_b16 v[72:73], v4 offset:16384
    ds_read_b64_tr_b16 v[74:75], v4 offset:18432
    v_mfma_f32_16x16x32_bf16 v[40:43], v[96:99], v[104:107], v[40:43]
    ds_read_b64_tr_b16 v[76:77], v5 offset:16384
    ds_read_b64_tr_b16 v[78:79], v5 offset:18432
    v_mfma_f32_16x16x32_bf16 v[44:47], v[96:99], v[108:111], v[44:47]
    ds_read_b64_tr_b16 v[80:81], v6 offset:16384
    v_mfma_f32_16x16x32_bf16 v[48:51], v[100:103], v[104:107], v[48:51]
    ds_read_b64_tr_b16 v[82:83], v6 offset:18432
    ds_read_b64_tr_b16 v[84:85], v7 offset:16384
    v_mfma_f32_16x16x32_bf16 v[52:55], v[100:103], v[108:111], v[52:55]
    ds_read_b64_tr_b16 v[86:87], v7 offset:18432
    s_waitcnt vmcnt(4) lgkmcnt(9)
    v_mfma_f32_16x16x32_bf16 v[24:27], v[56:59], v[112:115], v[24:27]
    s_cmp_lt_u32 s59, 12
    s_cbranch_scc1 P2_FULL12
P2_FULL12_OK:
    s_waitcnt lgkmcnt(8)
    v_readfirstlane_b32 s36, v3
    s_nop 0
    s_or_b32 s45, s45, s36
    s_and_b32 s36, s45, s56
    s_cmp_lg_u32 s36, s56
    s_cbranch_scc1 P2_G12
P2_G12_OK:
    v_mfma_f32_16x16x32_bf16 v[28:31], v[56:59], v[116:119], v[28:31]
    ds_read_b32 v23, v22
    buffer_load_dwordx4 v[104:107], v16, s[16:19], s12 offen sc1
    v_mfma_f32_16x16x32_bf16 v[32:35], v[60:63], v[112:115], v[32:35]
    ds_read_b64_tr_b16 v[88:89], v4 offset:32768
    v_mfma_f32_16x16x32_bf16 v[36:39], v[60:63], v[116:119], v[36:39]
    buffer_load_dwordx4 v[108:111], v17, s[16:19], s12 offen sc1
    ds_read_b64_tr_b16 v[90:91], v4 offset:34816
    v_mfma_f32_16x16x32_bf16 v[40:43], v[64:67], v[112:115], v[40:43]
    ds_read_b64_tr_b16 v[92:93], v5 offset:32768
    ds_read_b64_tr_b16 v[94:95], v5 offset:34816
    v_mfma_f32_16x16x32_bf16 v[44:47], v[64:67], v[116:119], v[44:47]
    ds_read_b64_tr_b16 v[96:97], v6 offset:32768
    v_mfma_f32_16x16x32_bf16 v[48:51], v[68:71], v[112:115], v[48:51]
    ds_read_b64_tr_b16 v[98:99], v6 offset:34816
    ds_read_b64_tr_b16 v[100:101], v7 offset:32768
    v_mfma_f32_16x16x32_bf16 v[52:55], v[68:71], v[116:119], v[52:55]
    ds_read_b64_tr_b16 v[102:103], v7 offset:34816
    s_waitcnt vmcnt(4) lgkmcnt(8)
    v_mfma_f32_16x16x32_bf16 v[24:27], v[72:75], v[120:123], v[24:27]
    v_readfirstlane_b32 s59, v23
    s_nop 0
    s_cmp_lt_u32 s59, 13
    s_cbranch_scc1 P2_FULL13
P2_FULL13_OK:
    v_mfma_f32_16x16x32_bf16 v[28:31], v[72:75], v[124:127], v[28:31]
    buffer_load_dwordx4 v[112:115], v16, s[16:19], s13 offen sc1
    ds_read_b64_tr_b16 v[56:57], v4 offset:49152
    v_mfma_f32_16x16x32_bf16 v[32:35], v[76:79], v[120:123], v[32:35]
    buffer_load_dwordx4 v[116:119], v17, s[16:19], s13 offen sc1
    v_mfma_f32_16x16x32_bf16 v[36:39], v[76:79], v[124:127], v[36:39]
    ds_read_b64_tr_b16 v[58:59], v4 offset:51200
    ds_read_b64_tr_b16 v[60:61], v5 offset:49152
    v_mfma_f32_16x16x32_bf16 v[40:43], v[80:83], v[120:123], v[40:43]
    ds_read_b64_tr_b16 v[62:63], v5 offset:51200
    ds_read_b64_tr_b16 v[64:65], v6 offset:49152
    v_mfma_f32_16x16x32_bf16 v[44:47], v[80:83], v[124:127], v[44:47]
    ds_read_b64_tr_b16 v[66:67], v6 offset:51200
    v_mfma_f32_16x16x32_bf16 v[48:51], v[84:87], v[120:123], v[48:51]
    ds_read_b64_tr_b16 v[68:69], v7 offset:49152
    ds_read_b64_tr_b16 v[70:71], v7 offset:51200
    v_mfma_f32_16x16x32_bf16 v[52:55], v[84:87], v[124:127], v[52:55]
    v_mov_b32 v21, 13
    ds_write_b32 v20, v21
    s_waitcnt vmcnt(4) lgkmcnt(9)
    v_mfma_f32_16x16x32_bf16 v[24:27], v[88:91], v[128:131], v[24:27]
    s_cmp_lt_u32 s59, 14
    s_cbranch_scc1 P2_FULL14
P2_FULL14_OK:
    buffer_load_dwordx4 v[120:123], v16, s[16:19], s14 offen sc1
    v_mfma_f32_16x16x32_bf16 v[28:31], v[88:91], v[132:135], v[28:31]
    ds_read_b32 v23, v22
    v_mfma_f32_16x16x32_bf16 v[32:35], v[92:95], v[128:131], v[32:35]
    buffer_load_dwordx4 v[124:127], v17, s[16:19], s14 offen sc1
    ds_read_b64_tr_b16 v[72:73], v8 offset:0
    v_mfma_f32_16x16x32_bf16 v[36:39], v[92:95], v[132:135], v[36:39]
    ds_read_b64_tr_b16 v[74:75], v8 offset:2048
    v_mfma_f32_16x16x32_bf16 v[40:43], v[96:99], v[128:131], v[40:43]
    ds_read_b64_tr_b16 v[76:77], v9 offset:0
    ds_read_b64_tr_b16 v[78:79], v9 offset:2048
    v_mfma_f32_16x16x32_bf16 v[44:47], v[96:99], v[132:135], v[44:47]
    ds_read_b64_tr_b16 v[80:81], v10 offset:0
    v_mfma_f32_16x16x32_bf16 v[48:51], v[100:103], v[128:131], v[48:51]
    ds_read_b64_tr_b16 v[82:83], v10 offset:2048
    ds_read_b64_tr_b16 v[84:85], v11 offset:0
    v_mfma_f32_16x16x32_bf16 v[52:55], v[100:103], v[132:135], v[52:55]
    ds_read_b64_tr_b16 v[86:87], v11 offset:2048
    s_setprio 0
    s_waitcnt vmcnt(4) lgkmcnt(8)
    v_mfma_f32_16x16x32_bf16 v[24:27], v[56:59], v[104:107], v[24:27]
    v_readfirstlane_b32 s59, v23
    s_nop 0
    s_cmp_lt_u32 s59, 15
    s_cbranch_scc1 P2_FULL15
P2_FULL15_OK:
    v_mfma_f32_16x16x32_bf16 v[28:31], v[56:59], v[108:111], v[28:31]
    buffer_load_dwordx4 v[128:131], v16, s[16:19], s15 offen sc1
    v_mfma_f32_16x16x32_bf16 v[32:35], v[60:63], v[104:107], v[32:35]
    ds_read_b64_tr_b16 v[88:89], v8 offset:16384
    buffer_load_dwordx4 v[132:135], v17, s[16:19], s15 offen sc1
    v_mfma_f32_16x16x32_bf16 v[36:39], v[60:63], v[108:111], v[36:39]
    ds_read_b64_tr_b16 v[90:91], v8 offset:18432
    v_mfma_f32_16x16x32_bf16 v[40:43], v[64:67], v[104:107], v[40:43]
    ds_read_b64_tr_b16 v[92:93], v9 offset:16384
    ds_read_b64_tr_b16 v[94:95], v9 offset:18432
    v_mfma_f32_16x16x32_bf16 v[44:47], v[64:67], v[108:111], v[44:47]
    ds_read_b64_tr_b16 v[96:97], v10 offset:16384
    v_mfma_f32_16x16x32_bf16 v[48:51], v[68:71], v[104:107], v[48:51]
    ds_read_b64_tr_b16 v[98:99], v10 offset:18432
    ds_read_b64_tr_b16 v[100:101], v11 offset:16384
    v_mfma_f32_16x16x32_bf16 v[52:55], v[68:71], v[108:111], v[52:55]
    ds_read_b64_tr_b16 v[102:103], v11 offset:18432
    s_waitcnt vmcnt(4) lgkmcnt(8)
    v_mfma_f32_16x16x32_bf16 v[24:27], v[72:75], v[112:115], v[24:27]
    s_cmp_lt_u32 s59, 16
    s_cbranch_scc1 P2_FULL16
P2_FULL16_OK:
    buffer_load_dwordx4 v[104:107], v16, s[16:19], s20 offen sc1
    v_mfma_f32_16x16x32_bf16 v[28:31], v[72:75], v[116:119], v[28:31]
    ds_read_b32 v23, v22
    v_mfma_f32_16x16x32_bf16 v[32:35], v[76:79], v[112:115], v[32:35]
    buffer_load_dwordx4 v[108:111], v17, s[16:19], s20 offen sc1
    ds_read_b64_tr_b16 v[56:57], v8 offset:32768
    v_mfma_f32_16x16x32_bf16 v[36:39], v[76:79], v[116:119], v[36:39]
    ds_read_b64_tr_b16 v[58:59], v8 offset:34816
    v_mfma_f32_16x16x32_bf16 v[40:43], v[80:83], v[112:115], v[40:43]
    ds_read_b64_tr_b16 v[60:61], v9 offset:32768
    ds_read_b64_tr_b16 v[62:63], v9 offset:34816
    v_mfma_f32_16x16x32_bf16 v[44:47], v[80:83], v[116:119], v[44:47]
    ds_read_b64_tr_b16 v[64:65], v10 offset:32768
    v_mfma_f32_16x16x32_bf16 v[48:51], v[84:87], v[112:115], v[48:51]
    ds_read_b64_tr_b16 v[66:67], v10 offset:34816
    ds_read_b64_tr_b16 v[68:69], v11 offset:32768
    v_mfma_f32_16x16x32_bf16 v[52:55], v[84:87], v[116:119], v[52:55]
    ds_read_b64_tr_b16 v[70:71], v11 offset:34816
    s_waitcnt vmcnt(4) lgkmcnt(8)
    v_mfma_f32_16x16x32_bf16 v[24:27], v[88:91], v[120:123], v[24:27]
    v_readfirstlane_b32 s59, v23
    s_nop 0
    s_cmp_lt_u32 s59, 17
    s_cbranch_scc1 P2_FULL17
P2_FULL17_OK:
    v_mfma_f32_16x16x32_bf16 v[28:31], v[88:91], v[124:127], v[28:31]
    buffer_load_dwordx4 v[112:115], v16, s[16:19], s21 offen sc1
    v_mfma_f32_16x16x32_bf16 v[32:35], v[92:95], v[120:123], v[32:35]
    ds_read_b64_tr_b16 v[72:73], v8 offset:49152
    buffer_load_dwordx4 v[116:119], v17, s[16:19], s21 offen sc1
    v_mfma_f32_16x16x32_bf16 v[36:39], v[92:95], v[124:127], v[36:39]
    ds_read_b64_tr_b16 v[74:75], v8 offset:51200
    v_mfma_f32_16x16x32_bf16 v[40:43], v[96:99], v[120:123], v[40:43]
    ds_read_b64_tr_b16 v[76:77], v9 offset:49152
    ds_read_b64_tr_b16 v[78:79], v9 offset:51200
    v_mfma_f32_16x16x32_bf16 v[44:47], v[96:99], v[124:127], v[44:47]
    ds_read_b64_tr_b16 v[80:81], v10 offset:49152
    v_mfma_f32_16x16x32_bf16 v[48:51], v[100:103], v[120:123], v[48:51]
    ds_read_b64_tr_b16 v[82:83], v10 offset:51200
    ds_read_b64_tr_b16 v[84:85], v11 offset:49152
    v_mfma_f32_16x16x32_bf16 v[52:55], v[100:103], v[124:127], v[52:55]
    ds_read_b64_tr_b16 v[86:87], v11 offset:51200
    s_waitcnt vmcnt(4) lgkmcnt(8)
    v_mfma_f32_16x16x32_bf16 v[24:27], v[56:59], v[128:131], v[24:27]
    s_cmp_lt_u32 s59, 18
    s_cbranch_scc1 P2_FULL18
P2_FULL18_OK:
    buffer_load_dwordx4 v[160:163], v18, s[8:11], 0 offen
    v_mfma_f32_16x16x32_bf16 v[28:31], v[56:59], v[132:135], v[28:31]
    ds_read_b64_tr_b16 v[88:89], v12 offset:0
    v_mfma_f32_16x16x32_bf16 v[32:35], v[60:63], v[128:131], v[32:35]
    ds_read_b64_tr_b16 v[90:91], v12 offset:2048
    v_mfma_f32_16x16x32_bf16 v[36:39], v[60:63], v[132:135], v[36:39]
    ds_read_b64_tr_b16 v[92:93], v13 offset:0
    v_mfma_f32_16x16x32_bf16 v[40:43], v[64:67], v[128:131], v[40:43]
    ds_read_b64_tr_b16 v[94:95], v13 offset:2048
    ds_read_b64_tr_b16 v[96:97], v14 offset:0
    v_mfma_f32_16x16x32_bf16 v[44:47], v[64:67], v[132:135], v[44:47]
    ds_read_b64_tr_b16 v[98:99], v14 offset:2048
    v_mfma_f32_16x16x32_bf16 v[48:51], v[68:71], v[128:131], v[48:51]
    ds_read_b64_tr_b16 v[100:101], v15 offset:0
    v_mfma_f32_16x16x32_bf16 v[52:55], v[68:71], v[132:135], v[52:55]
    ds_read_b64_tr_b16 v[102:103], v15 offset:2048
    s_waitcnt vmcnt(3) lgkmcnt(8)
    v_mfma_f32_16x16x32_bf16 v[24:27], v[72:75], v[104:107], v[24:27]
    s_xor_b32 s36, s57, 4
    v_mov_b32 v2, s36
    ds_read_b32 v3, v2
    v_mfma_f32_16x16x32_bf16 v[28:31], v[72:75], v[108:111], v[28:31]
    v_mfma_f32_16x16x32_bf16 v[32:35], v[76:79], v[104:107], v[32:35]
    v_mfma_f32_16x16x32_bf16 v[36:39], v[76:79], v[108:111], v[36:39]
    v_mfma_f32_16x16x32_bf16 v[40:43], v[80:83], v[104:107], v[40:43]
    v_mfma_f32_16x16x32_bf16 v[44:47], v[80:83], v[108:111], v[44:47]
    v_mfma_f32_16x16x32_bf16 v[48:51], v[84:87], v[104:107], v[48:51]
    v_mfma_f32_16x16x32_bf16 v[52:55], v[84:87], v[108:111], v[52:55]
    s_waitcnt vmcnt(1) lgkmcnt(1)
    v_mfma_f32_16x16x32_bf16 v[24:27], v[88:91], v[112:115], v[24:27]
    v_mfma_f32_16x16x32_bf16 v[28:31], v[88:91], v[116:119], v[28:31]
    v_mfma_f32_16x16x32_bf16 v[32:35], v[92:95], v[112:115], v[32:35]
    v_mfma_f32_16x16x32_bf16 v[36:39], v[92:95], v[116:119], v[36:39]
    v_mfma_f32_16x16x32_bf16 v[40:43], v[96:99], v[112:115], v[40:43]
    v_mfma_f32_16x16x32_bf16 v[44:47], v[96:99], v[116:119], v[44:47]
    v_mfma_f32_16x16x32_bf16 v[48:51], v[100:103], v[112:115], v[48:51]
    v_mfma_f32_16x16x32_bf16 v[52:55], v[100:103], v[116:119], v[52:55]
    s_waitcnt lgkmcnt(0)
    v_readfirstlane_b32 s36, v3
    s_nop 0
    s_cmp_lt_u32 s36, 13
    s_cbranch_scc1 P2_PART
P2_PART_OK:
    ds_write_b128 v148, v[24:27] offset:0
    ds_write_b128 v148, v[28:31] offset:16384
    ds_write_b128 v149, v[32:35] offset:0
    ds_write_b128 v149, v[36:39] offset:16384
    ds_write_b128 v150, v[40:43] offset:0
    ds_write_b128 v150, v[44:47] offset:16384
    ds_write_b128 v151, v[48:51] offset:0
    ds_write_b128 v151, v[52:55] offset:16384
    s_mov_b32 s8, s68
    s_mov_b32 s9, s69
    s_waitcnt vmcnt(0)
    v_lshlrev_b32 v4, 16, v160
    v_and_b32 v5, 0xffff0000, v160
    v_lshlrev_b32 v6, 16, v161
    v_and_b32 v7, 0xffff0000, v161
    v_lshlrev_b32 v8, 16, v162
    v_and_b32 v9, 0xffff0000, v162
    v_lshlrev_b32 v10, 16, v163
    v_and_b32 v11, 0xffff0000, v163
    s_waitcnt lgkmcnt(0)
    s_barrier
    ds_read_b128 v[56:59], v152 offset:0
    ds_read_b128 v[60:63], v153 offset:0
    ds_read_b128 v[64:67], v152 offset:4096
    ds_read_b128 v[68:71], v153 offset:4096
    ds_read_b128 v[72:75], v152 offset:8192
    ds_read_b128 v[76:79], v153 offset:8192
    ds_read_b128 v[80:83], v152 offset:12288
    ds_read_b128 v[84:87], v153 offset:12288
    s_waitcnt lgkmcnt(4)
    v_pk_add_f32 v[4:5], v[4:5], v[56:57]
    v_pk_add_f32 v[4:5], v[4:5], v[64:65]
    v_pk_add_f32 v[6:7], v[6:7], v[58:59]
    v_pk_add_f32 v[6:7], v[6:7], v[66:67]
    v_pk_add_f32 v[8:9], v[8:9], v[60:61]
    v_pk_add_f32 v[8:9], v[8:9], v[68:69]
    v_pk_add_f32 v[10:11], v[10:11], v[62:63]
    v_pk_add_f32 v[10:11], v[10:11], v[70:71]
    s_waitcnt lgkmcnt(0)
    v_pk_add_f32 v[72:73], v[72:73], v[80:81]
    v_pk_add_f32 v[4:5], v[4:5], v[72:73]
    v_cvt_pk_bf16_f32 v160, v4, v5
    v_pk_add_f32 v[74:75], v[74:75], v[82:83]
    v_pk_add_f32 v[6:7], v[6:7], v[74:75]
    v_cvt_pk_bf16_f32 v161, v6, v7
    v_pk_add_f32 v[76:77], v[76:77], v[84:85]
    v_pk_add_f32 v[8:9], v[8:9], v[76:77]
    v_cvt_pk_bf16_f32 v162, v8, v9
    v_pk_add_f32 v[78:79], v[78:79], v[86:87]
    v_pk_add_f32 v[10:11], v[10:11], v[78:79]
    v_cvt_pk_bf16_f32 v163, v10, v11
    buffer_store_dwordx4 v[160:163], v18, s[8:11], 0 offen sc1
L_END:
    s_endpgm
QKV_LF7:
    s_mov_b32 s60, 0
QKV_LF7_L:
    s_sleep 1
    ds_read_b32 v37, v36 offset:192
    s_add_u32 s60, s60, 1
    s_cmp_ge_u32 s60, 1048576
    s_cbranch_scc1 QKV_LF7_OK
    s_waitcnt lgkmcnt(0)
    v_readfirstlane_b32 s36, v37
    s_nop 0
    s_cmp_lt_u32 s36, 4
    s_cbranch_scc1 QKV_LF7_L
    s_branch QKV_LF7_OK
QKV_SSP:
    s_mov_b32 s60, 0
QKV_SSP_L:
    s_sleep 1
    ds_read_b32 v37, v36 offset:8
    s_add_u32 s60, s60, 1
    s_cmp_ge_u32 s60, 1048576
    s_cbranch_scc1 QKV_SSP_OK
    s_waitcnt lgkmcnt(0)
    v_readfirstlane_b32 s36, v37
    s_nop 0
    s_cmp_lt_u32 s36, 4
    s_cbranch_scc1 QKV_SSP_L
    s_branch QKV_SSP_OK
FFN4_LF7:
    s_mov_b32 s60, 0
FFN4_LF7_L:
    s_sleep 1
    ds_read_b32 v37, v36 offset:192
    s_add_u32 s60, s60, 1
    s_cmp_ge_u32 s60, 1048576
    s_cbranch_scc1 FFN4_LF7_OK
    s_waitcnt lgkmcnt(0)
    v_readfirstlane_b32 s36, v37
    s_nop 0
    s_cmp_lt_u32 s36, 4
    s_cbranch_scc1 FFN4_LF7_L
    s_branch FFN4_LF7_OK
FFN4_SSP:
    s_mov_b32 s60, 0
FFN4_SSP_L:
    s_sleep 1
    ds_read_b32 v37, v36 offset:8
    s_add_u32 s60, s60, 1
    s_cmp_ge_u32 s60, 1048576
    s_cbranch_scc1 FFN4_SSP_OK
    s_waitcnt lgkmcnt(0)
    v_readfirstlane_b32 s36, v37
    s_nop 0
    s_cmp_lt_u32 s36, 4
    s_cbranch_scc1 FFN4_SSP_L
    s_branch FFN4_SSP_OK
FFN3_LF7:
    s_mov_b32 s60, 0
FFN3_LF7_L:
    s_sleep 1
    ds_read_b32 v37, v36 offset:192
    s_add_u32 s60, s60, 1
    s_cmp_ge_u32 s60, 1048576
    s_cbranch_scc1 FFN3_LF7_OK
    s_waitcnt lgkmcnt(0)
    v_readfirstlane_b32 s36, v37
    s_nop 0
    s_cmp_lt_u32 s36, 4
    s_cbranch_scc1 FFN3_LF7_L
    s_branch FFN3_LF7_OK
FFN3_SSP:
    s_mov_b32 s60, 0
FFN3_SSP_L:
    s_sleep 1
    ds_read_b32 v37, v36 offset:8
    s_add_u32 s60, s60, 1
    s_cmp_ge_u32 s60, 1048576
    s_cbranch_scc1 FFN3_SSP_OK
    s_waitcnt lgkmcnt(0)
    v_readfirstlane_b32 s36, v37
    s_nop 0
    s_cmp_lt_u32 s36, 4
    s_cbranch_scc1 FFN3_SSP_L
    s_branch FFN3_SSP_OK
P2_G0:
    s_mov_b32 s60, 0
P2_G0_L:
    s_load_dword s45, s[16:17], s41 glc
    s_add_u32 s60, s60, 1
    s_cmp_ge_u32 s60, 262144
    s_waitcnt lgkmcnt(0)
    s_cbranch_scc1 P2_G0_OK
    s_and_b32 s36, s45, s43
    s_cmp_eq_u32 s36, s43
    s_cbranch_scc1 P2_G0_OK
    s_sleep 1
    s_branch P2_G0_L
P2_FULL2:
    s_mov_b32 s60, 0
P2_FULL2_L:
    ds_read_b32 v23, v22
    s_add_u32 s60, s60, 1
    s_cmp_ge_u32 s60, 1048576
    s_cbranch_scc1 P2_FULL2_OK
    s_waitcnt lgkmcnt(0)
    v_readfirstlane_b32 s59, v23
    s_nop 0
    s_cmp_ge_u32 s59, 2
    s_cbranch_scc1 P2_FULL2_OK
    s_sleep 1
    s_branch P2_FULL2_L
P2_FULL3:
    s_mov_b32 s60, 0
P2_FULL3_L:
    ds_read_b32 v23, v22
    s_add_u32 s60, s60, 1
    s_cmp_ge_u32 s60, 1048576
    s_cbranch_scc1 P2_FULL3_OK
    s_waitcnt lgkmcnt(0)
    v_readfirstlane_b32 s59, v23
    s_nop 0
    s_cmp_ge_u32 s59, 3
    s_cbranch_scc1 P2_FULL3_OK
    s_sleep 1
    s_branch P2_FULL3_L
P2_FULL4:
    s_mov_b32 s60, 0
P2_FULL4_L:
    ds_read_b32 v23, v22
    s_add_u32 s60, s60, 1
    s_cmp_ge_u32 s60, 1048576
    s_cbranch_scc1 P2_FULL4_OK
    s_waitcnt lgkmcnt(0)
    v_readfirstlane_b32 s59, v23
    s_nop 0
    s_cmp_ge_u32 s59, 4
    s_cbranch_scc1 P2_FULL4_OK
    s_sleep 1
    s_branch P2_FULL4_L
P2_G4:
    s_mov_b32 s60, 0
P2_G4_L:
    s_load_dword s45, s[16:17], s41 glc
    s_add_u32 s60, s60, 1
    s_cmp_ge_u32 s60, 262144
    s_waitcnt lgkmcnt(0)
    s_cbranch_scc1 P2_G4_OK
    s_and_b32 s36, s45, s62
    s_cmp_eq_u32 s36, s62
    s_cbranch_scc1 P2_G4_OK
    s_sleep 1
    s_branch P2_G4_L
P2_FULL5:
    s_mov_b32 s60, 0
P2_FULL5_L:
    ds_read_b32 v23, v22
    s_add_u32 s60, s60, 1
    s_cmp_ge_u32 s60, 1048576
    s_cbranch_scc1 P2_FULL5_OK
    s_waitcnt lgkmcnt(0)
    v_readfirstlane_b32 s59, v23
    s_nop 0
    s_cmp_ge_u32 s59, 5
    s_cbranch_scc1 P2_FULL5_OK
    s_sleep 1
    s_branch P2_FULL5_L
P2_FULL6:
    s_mov_b32 s60, 0
P2_FULL6_L:
    ds_read_b32 v23, v22
    s_add_u32 s60, s60, 1
    s_cmp_ge_u32 s60, 1048576
    s_cbranch_scc1 P2_FULL6_OK
    s_waitcnt lgkmcnt(0)
    v_readfirstlane_b32 s59, v23
    s_nop 0
    s_cmp_ge_u32 s59, 6
    s_cbranch_scc1 P2_FULL6_OK
    s_sleep 1
    s_branch P2_FULL6_L
P2_FULL7:
    s_mov_b32 s60, 0
P2_FULL7_L:
    ds_read_b32 v23, v22
    s_add_u32 s60, s60, 1
    s_cmp_ge_u32 s60, 1048576
    s_cbranch_scc1 P2_FULL7_OK
    s_waitcnt lgkmcnt(0)
    v_readfirstlane_b32 s59, v23
    s_nop 0
    s_cmp_ge_u32 s59, 7
    s_cbranch_scc1 P2_FULL7_OK
    s_sleep 1
    s_branch P2_FULL7_L
P2_FULL8:
    s_mov_b32 s60, 0
P2_FULL8_L:
    ds_read_b32 v23, v22
    s_add_u32 s60, s60, 1
    s_cmp_ge_u32 s60, 1048576
    s_cbranch_scc1 P2_FULL8_OK
    s_waitcnt lgkmcnt(0)
    v_readfirstlane_b32 s59, v23
    s_nop 0
    s_cmp_ge_u32 s59, 8
    s_cbranch_scc1 P2_FULL8_OK
    s_sleep 1
    s_branch P2_FULL8_L
P2_G8:
    s_mov_b32 s60, 0
P2_G8_L:
    s_load_dword s45, s[16:17], s41 glc
    s_add_u32 s60, s60, 1
    s_cmp_ge_u32 s60, 262144
    s_waitcnt lgkmcnt(0)
    s_cbranch_scc1 P2_G8_OK
    s_and_b32 s36, s45, s42
    s_cmp_eq_u32 s36, s42
    s_cbranch_scc1 P2_G8_OK
    s_sleep 1
    s_branch P2_G8_L
P2_FULL9:
    s_mov_b32 s60, 0
P2_FULL9_L:
    ds_read_b32 v23, v22
    s_add_u32 s60, s60, 1
    s_cmp_ge_u32 s60, 1048576
    s_cbranch_scc1 P2_FULL9_OK
    s_waitcnt lgkmcnt(0)
    v_readfirstlane_b32 s59, v23
    s_nop 0
    s_cmp_ge_u32 s59, 9
    s_cbranch_scc1 P2_FULL9_OK
    s_sleep 1
    s_branch P2_FULL9_L
P2_FULL10:
    s_mov_b32 s60, 0
P2_FULL10_L:
    ds_read_b32 v23, v22
    s_add_u32 s60, s60, 1
    s_cmp_ge_u32 s60, 1048576
    s_cbranch_scc1 P2_FULL10_OK
    s_waitcnt lgkmcnt(0)
    v_readfirstlane_b32 s59, v23
    s_nop 0
    s_cmp_ge_u32 s59, 10
    s_cbranch_scc1 P2_FULL10_OK
    s_sleep 1
    s_branch P2_FULL10_L
P2_FULL11:
    s_mov_b32 s60, 0
P2_FULL11_L:
    ds_read_b32 v23, v22
    s_add_u32 s60, s60, 1
    s_cmp_ge_u32 s60, 1048576
    s_cbranch_scc1 P2_FULL11_OK
    s_waitcnt lgkmcnt(0)
    v_readfirstlane_b32 s59, v23
    s_nop 0
    s_cmp_ge_u32 s59, 11
    s_cbranch_scc1 P2_FULL11_OK
    s_sleep 1
    s_branch P2_FULL11_L
P2_FULL12:
    s_mov_b32 s60, 0
P2_FULL12_L:
    ds_read_b32 v23, v22
    s_add_u32 s60, s60, 1
    s_cmp_ge_u32 s60, 1048576
    s_cbranch_scc1 P2_FULL12_OK
    s_waitcnt lgkmcnt(0)
    v_readfirstlane_b32 s59, v23
    s_nop 0
    s_cmp_ge_u32 s59, 12
    s_cbranch_scc1 P2_FULL12_OK
    s_sleep 1
    s_branch P2_FULL12_L
P2_G12:
    s_mov_b32 s60, 0
P2_G12_L:
    s_load_dword s45, s[16:17], s41 glc
    s_add_u32 s60, s60, 1
    s_cmp_ge_u32 s60, 262144
    s_waitcnt lgkmcnt(0)
    s_cbranch_scc1 P2_G12_OK
    s_and_b32 s36, s45, s56
    s_cmp_eq_u32 s36, s56
    s_cbranch_scc1 P2_G12_OK
    s_sleep 1
    s_branch P2_G12_L
P2_FULL13:
    s_mov_b32 s60, 0
P2_FULL13_L:
    ds_read_b32 v23, v22
    s_add_u32 s60, s60, 1
    s_cmp_ge_u32 s60, 1048576
    s_cbranch_scc1 P2_FULL13_OK
    s_waitcnt lgkmcnt(0)
    v_readfirstlane_b32 s59, v23
    s_nop 0
    s_cmp_ge_u32 s59, 13
    s_cbranch_scc1 P2_FULL13_OK
    s_sleep 1
    s_branch P2_FULL13_L
P2_FULL14:
    s_mov_b32 s60, 0
P2_FULL14_L:
    ds_read_b32 v23, v22
    s_add_u32 s60, s60, 1
    s_cmp_ge_u32 s60, 1048576
    s_cbranch_scc1 P2_FULL14_OK
    s_waitcnt lgkmcnt(0)
    v_readfirstlane_b32 s59, v23
    s_nop 0
    s_cmp_ge_u32 s59, 14
    s_cbranch_scc1 P2_FULL14_OK
    s_sleep 1
    s_branch P2_FULL14_L
P2_FULL15:
    s_mov_b32 s60, 0
P2_FULL15_L:
    ds_read_b32 v23, v22
    s_add_u32 s60, s60, 1
    s_cmp_ge_u32 s60, 1048576
    s_cbranch_scc1 P2_FULL15_OK
    s_waitcnt lgkmcnt(0)
    v_readfirstlane_b32 s59, v23
    s_nop 0
    s_cmp_ge_u32 s59, 15
    s_cbranch_scc1 P2_FULL15_OK
    s_sleep 1
    s_branch P2_FULL15_L
P2_FULL16:
    s_mov_b32 s60, 0
P2_FULL16_L:
    ds_read_b32 v23, v22
    s_add_u32 s60, s60, 1
    s_cmp_ge_u32 s60, 1048576
    s_cbranch_scc1 P2_FULL16_OK
    s_waitcnt lgkmcnt(0)
    v_readfirstlane_b32 s59, v23
    s_nop 0
    s_cmp_ge_u32 s59, 16
    s_cbranch_scc1 P2_FULL16_OK
    s_sleep 1
    s_branch P2_FULL16_L
P2_FULL17:
    s_mov_b32 s60, 0
P2_FULL17_L:
    ds_read_b32 v23, v22
    s_add_u32 s60, s60, 1
    s_cmp_ge_u32 s60, 1048576
    s_cbranch_scc1 P2_FULL17_OK
    s_waitcnt lgkmcnt(0)
    v_readfirstlane_b32 s59, v23
    s_nop 0
    s_cmp_ge_u32 s59, 17
    s_cbranch_scc1 P2_FULL17_OK
    s_sleep 1
    s_branch P2_FULL17_L
P2_FULL18:
    s_mov_b32 s60, 0
P2_FULL18_L:
    ds_read_b32 v23, v22
    s_add_u32 s60, s60, 1
    s_cmp_ge_u32 s60, 1048576
    s_cbranch_scc1 P2_FULL18_OK
    s_waitcnt lgkmcnt(0)
    v_readfirstlane_b32 s59, v23
    s_nop 0
    s_cmp_ge_u32 s59, 18
    s_cbranch_scc1 P2_FULL18_OK
    s_sleep 1
    s_branch P2_FULL18_L
P2_PART:
    s_mov_b32 s60, 0
P2_PART_L:
    s_sleep 1
    ds_read_b32 v3, v2 offset:0
    s_add_u32 s60, s60, 1
    s_cmp_ge_u32 s60, 1048576
    s_cbranch_scc1 P2_PART_OK
    s_waitcnt lgkmcnt(0)
    v_readfirstlane_b32 s36, v3
    s_nop 0
    s_cmp_lt_u32 s36, 13
    s_cbranch_scc1 P2_PART_L
    s_branch P2_PART_OK
L_CODE_END:
.section .rodata,"a"
.p2align 6
.amdhsa_kernel parallel_sum__sliding_local_dilated__dense_activation_silu__prompt_kernel
  .amdhsa_next_free_vgpr 168
  .amdhsa_next_free_sgpr 100
  .amdhsa_accum_offset 168
  .amdhsa_group_segment_fixed_size 0
  .amdhsa_kernarg_size 72
  .amdhsa_user_sgpr_count 2
  .amdhsa_user_sgpr_kernarg_segment_ptr 1
  .amdhsa_system_sgpr_workgroup_id_x 1
.end_amdhsa_kernel
```
